```python
import torch

def _softmax(x, axis=-1):
    return torch.softmax(x, dim=axis)
def _gelu(x):
    return torch.nn.functional.gelu(x, approximate="tanh")
def _silu(x):
    return torch.nn.functional.silu(x)
def _sigmoid(x):
    return torch.sigmoid(x)
def _layernorm(x, axis=-1, eps=1e-5):
    m = x.mean(dim=axis, keepdim=True)
    v = x.var(dim=axis, keepdim=True, unbiased=False)
    return (x - m) / torch.sqrt(v + eps)
def _scatter_add(tgt, idx, src, axis=0):
    return tgt.clone().index_add_(axis, idx, src)
def _segment_sum(src, seg, n):
    out = torch.zeros((n,) + src.shape[1:], dtype=src.dtype)
    return out.index_add_(0, seg, src)
def _pad(x, pw):
    flat = tuple(v for pair in reversed(pw) for v in pair)
    return torch.nn.functional.pad(x, flat)

kernel_name = 'recurrent_scan__gqa_block_cached__swiglu_ffn__decode'

def setup_inputs():

    _w = (lambda a: (lambda t: t.to(torch.bfloat16) if t.is_floating_point() else t)(torch.as_tensor(a)))
    def _A_setup():
        B, Sq, D = 2, 1, 576
        Hq, Hkv, Sk, Dh = 32, 16, 32768, 128
        assert Hq % Hkv == 0, (Hq, Hkv)
        return {
            "x": _w((lambda *s: torch.randn(*s, dtype=torch.bfloat16) * 0.05)(B, Sq, D)),
            "k_cache": _w((lambda *s: torch.randn(*s, dtype=torch.bfloat16) * 1.6)(B, Hkv, Sk, Dh)),
            "v_cache": _w((lambda *s: torch.randn(*s, dtype=torch.bfloat16) * 0.2)(B, Hkv, Sk, Dh)),
            "wq": _w((lambda *s: torch.randn(*s, dtype=torch.bfloat16) * 1.6)(D, Hq * Dh) * (D ** -0.5)),
            "wo": _w((lambda *s: torch.randn(*s, dtype=torch.bfloat16) * 0.2)(Hq * Dh, D) * ((Hq * Dh) ** -0.5)),
        }
    _A_in = _A_setup()

    def _B_setup():
        B, S, D, F = 2, 1, 576, 4608
        return {
            "x": _w((lambda *s: torch.randn(*s, dtype=torch.bfloat16) * 0.05)(B, S, D)),
            "w_gate": _w((lambda *s: torch.randn(*s, dtype=torch.bfloat16) * 0.1)(D, F)),
            "w_up": _w((lambda *s: torch.randn(*s, dtype=torch.bfloat16) * 0.1)(D, F)),
            "w_down": _w((lambda *s: torch.randn(*s, dtype=torch.bfloat16) * 0.1)(F, D)),
        }
    _B_in = _B_setup()

    return {
        "A_x": _A_in["x"],
        "A_k_cache": _A_in["k_cache"],
        "A_v_cache": _A_in["v_cache"],
        "A_wq": _A_in["wq"],
        "A_wo": _A_in["wo"],
        "B_x": _B_in["x"],
        "B_w_gate": _B_in["w_gate"],
        "B_w_up": _B_in["w_up"],
        "B_w_down": _B_in["w_down"],
    }

def reference(A_x, A_k_cache, A_v_cache, A_wq, A_wo, B_x, B_w_gate, B_w_up, B_w_down):
    def _A_ref(x, k_cache, v_cache, wq, wo):
        B, Sq, D = x.shape
        Hq, Dh = 32, 128
        Hkv = k_cache.shape[1]
        rep = Hq // Hkv
        q = (lambda x, *d: x.permute(*d))((x @ wq).reshape(B, Sq, Hq, Dh), 0, 2, 1, 3)
        k = (lambda x, n, axis: torch.repeat_interleave(x, n, dim=axis))(k_cache, rep, axis=1)
        v = (lambda x, n, axis: torch.repeat_interleave(x, n, dim=axis))(v_cache, rep, axis=1)
        scores = torch.einsum("bhqd,bhkd->bhqk", q, k) * (Dh ** -0.5)
        p = _softmax(scores, axis=-1)
        o = torch.einsum("bhqk,bhkd->bhqd", p, v)
        return (lambda x, *d: x.permute(*d))(o, 0, 2, 1, 3).reshape(B, Sq, Hq * Dh) @ wo

    def _B_ref(x, w_gate, w_up, w_down):
        g = _silu(x @ w_gate)
        u = x @ w_up
        return (g * u) @ w_down

    x = A_x
    xn = _layernorm(x, axis=-1)
    s = _A_ref(xn, A_k_cache, A_v_cache, A_wq, A_wo)
    g = _silu(_B_ref(xn, B_w_gate, B_w_up, B_w_down))
    return x + s * g
```

```asm
; @launch grid=(256,1,1) block=(320,1,1) lds=158848
.amdgcn_target "amdgcn-amd-amdhsa--gfx950"
.text
.globl recurrent_scan__gqa_block_cached__swiglu_ffn__decode_kernel
.p2align 8
.type recurrent_scan__gqa_block_cached__swiglu_ffn__decode_kernel,@function
recurrent_scan__gqa_block_cached__swiglu_ffn__decode_kernel:
    s_cmp_ge_u32 s2, 256
    s_cbranch_scc1 L_end
    s_load_dwordx16 s[4:19], s[0:1], 0
    s_load_dwordx8 s[20:27], s[0:1], 64
    v_lshrrev_b32 v1, 6, v0
    v_and_b32 v0, 63, v0
    v_readfirstlane_b32 s3, v1
    s_lshr_b32 s52, s2, 3
    s_and_b32 s53, s2, 7
    s_lshr_b32 s54, s2, 7
    s_and_b32 s55, s52, 15
    s_sub_u32 s72, s53, s52
    s_and_b32 s72, s72, 7
    s_cmp_le_u32 s72, 3
    s_cselect_b32 s56, 1, 2
    s_cselect_b32 s61, 1, 4
    s_sub_u32 s61, s72, s61
    s_and_b32 s57, s52, 7
    s_lshl_b32 s57, s57, 1
    s_add_u32 s57, s57, s61
    s_lshl_b32 s57, s57, 2
    s_lshr_b32 s62, s52, 3
    s_add_u32 s57, s57, s62
    s_lshr_b32 s62, s52, 3
    s_xor_b32 s62, s62, s52
    s_and_b32 s62, s62, 3
    s_cselect_b32 s62, 0, s56
    s_lshr_b32 s80, s52, 2
    s_add_u32 s80, s80, 64
    s_cmp_eq_u32 s61, 2
    s_cselect_b32 s56, s62, s56
    s_cselect_b32 s57, s80, s57
    s_lshl_b32 s73, s52, 1
    s_and_b32 s61, s72, 1
    s_add_u32 s73, s73, s61
    s_add_u32 s72, s72, 1
    s_and_b32 s72, s72, 6
    s_cselect_b32 s56, s56, 3
    s_cselect_b32 s57, s57, s73
    s_cmp_eq_u32 s3, 0
    s_cbranch_scc1 L_side
    s_sub_u32 s67, s3, 1
    s_lshl_b32 s74, s67, 15
    s_lshl_b32 s96, s53, 9
    s_add_u32 s58, s96, s74
    s_add_u32 s75, s58, 7077888
    v_bfe_u32 v8, v0, 2, 2
    v_lshlrev_b32 v8, 13, v8
    v_and_b32 v1, 3, v0
    v_lshl_add_u32 v8, v1, 6, v8
    v_lshrrev_b32 v1, 4, v0
    v_lshl_add_u32 v8, v1, 4, v8
    v_lshlrev_b32 v9, 13, v1
    v_and_b32 v1, 15, v0
    v_lshl_add_u32 v9, v1, 4, v9
    s_lshl_b32 s60, s67, 12
    s_add_u32 s60, s60, 27776
    s_mov_b32 s59, 8
    s_lshl_b32 s61, s52, 23
    s_mov_b32 s30, 8388608
    s_mov_b32 s31, 0x20000
    s_waitcnt lgkmcnt(0)
    s_add_u32 s28, s6, s61
    s_addc_u32 s29, s7, 0
    s_cmp_eq_u32 s56, 1
    s_cbranch_scc1 L_pro_ffn
L_pro_loop:
    s_add_u32 s99, s75, 4096
    s_add_u32 m0, s60, 0
    s_waitcnt vmcnt(5)
    buffer_load_dwordx4 v8, s[28:31], s75 offen offset:0 nt lds
    s_add_u32 m0, s60, 768
    s_waitcnt vmcnt(5)
    buffer_load_dwordx4 v8, s[28:31], s75 offen offset:256 nt lds
    s_add_u32 m0, s60, 2048
    s_waitcnt vmcnt(5)
    buffer_load_dwordx4 v8, s[28:31], s99 offen offset:0 nt lds
    s_add_u32 m0, s60, 2816
    s_waitcnt vmcnt(5)
    buffer_load_dwordx4 v8, s[28:31], s99 offen offset:256 nt lds
    s_add_u32 s60, s60, 16384
    s_add_u32 s75, s75, 131072
    s_sub_u32 s59, s59, 1
    s_cmp_lg_u32 s59, 0
    s_cbranch_scc1 L_pro_loop
    s_branch L_pro_join
L_pro_ffn:
    s_lshl_b32 s62, s57, 7
    s_add_u32 s40, s16, s62
    s_addc_u32 s41, s17, 0
    s_sub_u32 s42, 5308416, s62
    s_mov_b32 s43, 0x20000
    s_add_u32 s44, s18, s62
    s_addc_u32 s45, s19, 0
    s_sub_u32 s46, 5308416, s62
    s_mov_b32 s47, 0x20000
    v_lshrrev_b32 v1, 4, v0
    v_bfe_u32 v2, v0, 3, 1
    v_lshl_add_u32 v1, v2, 2, v1
    v_mul_u32_u24 v1, 9216, v1
    v_and_b32 v2, 7, v0
    v_lshl_add_u32 v1, v2, 4, v1
    s_mul_i32 s75, s67, 147456
    s_barrier
L_pf_loop:
    s_add_u32 s99, s75, 73728
    s_add_u32 m0, s60, 0
    s_waitcnt vmcnt(5)
    buffer_load_dwordx4 v1, s[40:43], s75 offen nt lds
    s_add_u32 m0, s60, 1024
    s_waitcnt vmcnt(5)
    buffer_load_dwordx4 v1, s[44:47], s75 offen nt lds
    s_add_u32 m0, s60, 2048
    s_waitcnt vmcnt(5)
    buffer_load_dwordx4 v1, s[40:43], s99 offen nt lds
    s_add_u32 m0, s60, 3072
    s_waitcnt vmcnt(5)
    buffer_load_dwordx4 v1, s[44:47], s99 offen nt lds
    s_add_u32 s60, s60, 16384
    s_add_u32 s75, s75, 589824
    s_sub_u32 s59, s59, 1
    s_cmp_lg_u32 s59, 0
    s_cbranch_scc1 L_pf_loop
L_pro_join:
    s_add_u32 s99, s58, 4096
    s_waitcnt vmcnt(5)
    buffer_load_dwordx4 v[64:67], v8, s[28:31], s58 offen offset:0 nt
    s_mov_b64 s[4:5], s[28:29]
    s_add_u32 s6, s8, s61
    s_addc_u32 s7, s9, 0
    s_mov_b32 s36, s26
    s_mov_b32 s37, s27
    s_mov_b32 s38, 4194304
    s_mov_b32 s39, 0x20000
    s_add_u32 s97, s96, 16908288
    s_add_u32 s98, s96, 33816576
    s_mov_b32 s63, 0x3db504f3
    s_mov_b32 s64, 0x3fb8aa3b
    s_mov_b32 s65, 0xbfb8aa3b
    s_mov_b32 s66, 0x40000
    s_mov_b32 s68, 0
    s_mov_b32 s69, -1
    s_mov_b32 s70, 0x00ff00ff
    s_mov_b32 s71, 0x00ff00ff
    v_and_b32 v1, 1, v0
    v_lshlrev_b32 v1, 4, v1
    v_mov_b32 v2, 0xffff
    v_lshlrev_b32 v1, v1, v2
    v_bfe_u32 v2, v0, 1, 2
    v_cmp_eq_u32 vcc, 0, v2
    s_nop 1
    v_cndmask_b32 v4, 0, v1, vcc
    v_cmp_eq_u32 vcc, 1, v2
    s_nop 1
    v_cndmask_b32 v5, 0, v1, vcc
    v_cmp_eq_u32 vcc, 2, v2
    s_nop 1
    v_cndmask_b32 v6, 0, v1, vcc
    v_cmp_eq_u32 vcc, 3, v2
    s_nop 1
    v_cndmask_b32 v7, 0, v1, vcc
    s_waitcnt vmcnt(5)
    buffer_load_dwordx4 v[68:71], v8, s[28:31], s58 offen offset:256 nt
    v_mov_b32 v10, 0xff800000
    v_mov_b32 v11, 0
    v_mov_b32 v20, 0
    v_mov_b32 v16, 0
    v_mov_b32 v17, 0
    v_mov_b32 v18, 0
    v_mov_b32 v19, 0
    v_lshrrev_b32 v3, 5, v0
    v_lshlrev_b32 v3, 9, v3
    v_and_b32 v2, 15, v0
    v_lshl_add_u32 v3, v2, 5, v3
    v_and_b32 v2, 16, v0
    v_add_u32 v3, v3, v2
    s_lshl_b32 s61, s67, 10
    v_add_u32 v3, s61, v3
    v_and_b32 v21, 8, v0
    s_lshl_b32 s61, s67, 4
    v_add_u32 v21, s61, v21
    v_and_b32 v113, 0x38, v0
    s_lshl_b32 s61, s67, 12
    v_add_u32 v113, s61, v113
    v_mov_b32 v114, v113
    v_lshlrev_b32 v115, 4, v0
    v_mov_b32 v22, 12
    v_mov_b32 v23, 0
    s_waitcnt vmcnt(5)
    buffer_load_dwordx4 v[72:75], v8, s[28:31], s99 offen offset:0 nt
    s_cmp_lg_u32 s56, 3
    s_cselect_b64 s[80:81], s[20:21], s[12:13]
    s_mov_b32 s62, 8192
    s_cselect_b32 s62, 9216, s62
    s_mov_b32 s14, 720896
    s_cselect_b32 s14, 1048576, s14
    s_mul_i32 s61, s57, 73728
    s_add_u32 s32, s80, s61
    s_addc_u32 s33, s81, 0
    s_mov_b32 s34, 73728
    s_mov_b32 s35, 0x20000
    s_lshl_b32 s61, s57, 7
    s_add_u32 s14, s14, s61
    s_lshl_b32 s61, s67, 2
    s_mul_i32 s61, s61, s62
    s_add_u32 s14, s14, s61
    s_lshl_b32 s61, s62, 2
    s_add_u32 s15, s14, s61
    v_lshrrev_b32 v118, 5, v0
    v_mul_u32_u24 v118, 18, v118
    v_bfe_u32 v2, v0, 2, 2
    v_add_u32 v118, v118, v2
    v_mul_u32_u24 v118, s62, v118
    v_and_b32 v2, 3, v0
    v_lshl_add_u32 v118, v2, 5, v118
    v_and_b32 v2, 16, v0
    v_add_u32 v118, v118, v2
    s_waitcnt vmcnt(5)
    buffer_load_dwordx4 v[76:79], v8, s[28:31], s99 offen offset:256 nt
    s_lshl_b32 s61, s55, 2
    s_add_u32 s61, s61, s54
    s_lshl_b32 s61, s61, 3
    s_add_u32 s61, s61, s53
    s_lshl_b32 s82, s61, 9
    s_add_u32 s82, s82, 393216
    s_lshl_b32 s83, s2, 7
    s_add_u32 s83, s83, 655360
    v_lshrrev_b32 v123, 5, v0
    v_lshlrev_b32 v123, 13, v123
    v_and_b32 v2, 0x1f0, v115
    v_add_u32 v123, v123, v2
    v_lshrrev_b32 v119, 4, v0
    v_mul_u32_u24 v119, 1152, v119
    v_and_b32 v2, 15, v0
    v_lshl_add_u32 v119, v2, 4, v119
    s_lshl_b32 s61, s67, 8
    v_add_u32 v119, s61, v119
    s_add_u32 s58, s58, 131072
    s_add_u32 s99, s58, 4096
    s_waitcnt vmcnt(5)
    buffer_load_dwordx4 v[80:83], v8, s[28:31], s58 offen offset:0 nt
    v_lshrrev_b32 v121, 3, v0
    v_lshlrev_b32 v120, 7, v121
    v_lshlrev_b32 v121, 9, v121
    v_and_b32 v2, 7, v0
    v_lshl_add_u32 v121, v2, 4, v121
    v_lshrrev_b32 v122, 4, v0
    v_lshlrev_b32 v122, 8, v122
    v_lshl_add_u32 v122, v2, 2, v122
    s_lshr_b32 s61, s67, 1
    s_lshl_b32 s61, s61, 7
    s_and_b32 s62, s67, 1
    s_lshl_b32 s62, s62, 5
    s_add_u32 s61, s61, s62
    v_add_u32 v122, s61, v122
    s_waitcnt vmcnt(5)
    buffer_load_dwordx4 v[84:87], v8, s[28:31], s58 offen offset:256 nt
    v_bfe_u32 v1, v0, 3, 1
    v_lshlrev_b32 v1, 8, v1
    v_and_b32 v2, 3, v0
    v_lshl_add_u32 v1, v2, 6, v1
    v_lshrrev_b32 v2, 4, v0
    v_lshl_add_u32 v1, v2, 4, v1
    s_lshl_b32 s61, s67, 2
    v_mov_b32 v2, s61
    s_waitcnt vmcnt(5)
    buffer_load_dwordx4 v[88:91], v8, s[28:31], s99 offen offset:0 nt
    s_waitcnt vmcnt(5)
    buffer_load_dwordx4 v[92:95], v8, s[28:31], s99 offen offset:256 nt
    s_barrier
    ds_read_b128 v[12:15], v1 offset:4608
    ds_read_b32 v23, v23 offset:10304
    v_lshrrev_b32 v1, 5, v0
    v_lshlrev_b32 v1, 3, v1
    s_waitcnt lgkmcnt(0)
    v_readfirstlane_b32 s61, v23
    s_nop 0
    s_add_u32 s76, s61, 1
    s_add_u32 s77, s61, 6
    s_add_u32 s78, s61, 11
    s_add_u32 s79, s61, 14
    s_setprio 1
L_loop:
    s_and_b32 s58, s98, 0x00fe0e00
    s_add_u32 s58, s58, s74
    s_add_u32 s99, s58, 4096
    s_bitcmp1_b32 s98, 1
    s_cselect_b64 s[28:29], s[6:7], s[4:5]
    s_cselect_b64 s[80:81], -1, 0
    v_cndmask_b32 v112, v8, v9, s[80:81]
    s_lshr_b32 s60, s97, 24
    s_lshl_b32 s60, s60, 6
    s_bitcmp1_b32 s96, 1
    s_cbranch_scc1 L_V0
    s_waitcnt vmcnt(4)
    buffer_load_dwordx4 v[96:99], v112, s[28:31], s58 offen offset:0 nt
    ds_write_b32 v2, v22 offset:10320
    v_mfma_f32_16x16x32_bf16 v[24:27], v[64:67], v[12:15], 0
    v_mfma_f32_16x16x32_bf16 v[28:31], v[68:71], v[12:15], 0
    v_mfma_f32_16x16x32_bf16 v[32:35], v[72:75], v[12:15], 0
    v_mfma_f32_16x16x32_bf16 v[36:39], v[76:79], v[12:15], 0
    s_waitcnt vmcnt(4)
    buffer_load_dwordx4 v[100:103], v112, s[28:31], s58 offen offset:256 nt
    s_nop 2
    v_mov_b32_dpp v40, v24 quad_perm:[0,0,0,0] row_mask:0xf bank_mask:0xf
    v_mov_b32_dpp v41, v28 quad_perm:[0,0,0,0] row_mask:0xf bank_mask:0xf
    v_mov_b32_dpp v42, v32 quad_perm:[0,0,0,0] row_mask:0xf bank_mask:0xf
    v_mov_b32_dpp v43, v36 quad_perm:[0,0,0,0] row_mask:0xf bank_mask:0xf
    v_add_f32_dpp v40, v25, v40 quad_perm:[1,1,1,1] row_mask:0xf bank_mask:0xf
    v_add_f32_dpp v41, v29, v41 quad_perm:[1,1,1,1] row_mask:0xf bank_mask:0xf
    v_add_f32_dpp v42, v33, v42 quad_perm:[1,1,1,1] row_mask:0xf bank_mask:0xf
    v_add_f32_dpp v43, v37, v43 quad_perm:[1,1,1,1] row_mask:0xf bank_mask:0xf
    v_add_f32_dpp v40, v26, v40 quad_perm:[2,2,2,2] row_mask:0xf bank_mask:0xf
    v_add_f32_dpp v41, v30, v41 quad_perm:[2,2,2,2] row_mask:0xf bank_mask:0xf
    v_add_f32_dpp v42, v34, v42 quad_perm:[2,2,2,2] row_mask:0xf bank_mask:0xf
    v_add_f32_dpp v43, v38, v43 quad_perm:[2,2,2,2] row_mask:0xf bank_mask:0xf
    v_add_f32_dpp v40, v27, v40 quad_perm:[3,3,3,3] row_mask:0xf bank_mask:0xf
    v_add_f32_dpp v41, v31, v41 quad_perm:[3,3,3,3] row_mask:0xf bank_mask:0xf
    v_add_f32_dpp v42, v35, v42 quad_perm:[3,3,3,3] row_mask:0xf bank_mask:0xf
    v_add_f32_dpp v43, v39, v43 quad_perm:[3,3,3,3] row_mask:0xf bank_mask:0xf
    s_waitcnt vmcnt(4)
    buffer_load_dwordx4 v[104:107], v112, s[28:31], s99 offen offset:0 nt
    ds_read_b32 v23, v22 offset:10368
    v_cvt_pk_bf16_f32 v44, v40, v41
    v_cvt_pk_bf16_f32 v45, v42, v43
    v_lshlrev_b32 v40, 16, v44
    v_and_b32 v41, 0xffff0000, v44
    v_lshlrev_b32 v42, 16, v45
    v_and_b32 v43, 0xffff0000, v45
    v_mul_f32 v40, s63, v40
    v_mul_f32 v41, s63, v41
    v_mul_f32 v42, s63, v42
    v_mul_f32 v43, s63, v43
    v_cvt_pk_bf16_f32 v44, v40, v41
    v_cvt_pk_bf16_f32 v45, v42, v43
    ds_write_b64 v114, v[44:45] offset:11392
    v_add_u32 v114, s60, v113
    ds_read_b64 v[116:117], v114 offset:11392
    s_waitcnt vmcnt(4)
    buffer_load_dwordx4 v[108:111], v112, s[28:31], s99 offen offset:256 nt
    s_branch L_tk0
L_V0:
    s_waitcnt vmcnt(4)
    buffer_load_dwordx4 v[96:99], v112, s[28:31], s58 offen offset:0 nt
    ds_write_b32 v2, v22 offset:10320
    v_lshlrev_b32 v40, 16, v116
    v_and_b32 v41, 0xffff0000, v116
    v_lshlrev_b32 v42, 16, v117
    v_and_b32 v43, 0xffff0000, v117
    v_max3_f32 v46, v40, v41, v42
    v_max_f32 v46, v46, v43
    v_cmp_gt_f32 vcc, v46, v10
    s_cbranch_vccnz L_resc0
L_back0:
    v_fma_f32 v40, v40, s64, v11
    v_fma_f32 v41, v41, s64, v11
    v_fma_f32 v42, v42, s64, v11
    v_fma_f32 v43, v43, s64, v11
    v_exp_f32 v40, v40
    v_exp_f32 v41, v41
    v_exp_f32 v42, v42
    v_exp_f32 v43, v43
    v_add_f32 v46, v40, v41
    v_add_f32 v47, v42, v43
    v_cvt_pk_bf16_f32 v40, v40, v40
    v_cvt_pk_bf16_f32 v41, v41, v41
    v_cvt_pk_bf16_f32 v42, v42, v42
    v_cvt_pk_bf16_f32 v43, v43, v43
    v_add_f32 v46, v46, v47
    v_add_f32 v20, v20, v46
    v_and_b32 v48, v40, v4
    v_and_b32 v49, v40, v5
    v_and_b32 v50, v40, v6
    v_and_b32 v51, v40, v7
    v_and_b32 v52, v41, v4
    v_and_b32 v53, v41, v5
    v_and_b32 v54, v41, v6
    v_and_b32 v55, v41, v7
    v_and_b32 v56, v42, v4
    v_and_b32 v57, v42, v5
    v_and_b32 v58, v42, v6
    v_and_b32 v59, v42, v7
    v_and_b32 v60, v43, v4
    v_and_b32 v61, v43, v5
    v_and_b32 v62, v43, v6
    v_and_b32 v63, v43, v7
    s_waitcnt vmcnt(4)
    buffer_load_dwordx4 v[100:103], v112, s[28:31], s58 offen offset:256 nt
    v_mfma_f32_16x16x32_bf16 v[16:19], v[48:51], v[64:67], v[16:19]
    v_mfma_f32_16x16x32_bf16 v[16:19], v[52:55], v[68:71], v[16:19]
    v_mfma_f32_16x16x32_bf16 v[16:19], v[56:59], v[72:75], v[16:19]
    v_mfma_f32_16x16x32_bf16 v[16:19], v[60:63], v[76:79], v[16:19]
    s_bitcmp1_b32 s97, 23
    s_cbranch_scc1 L_loop_done
    s_waitcnt vmcnt(4)
    buffer_load_dwordx4 v[104:107], v112, s[28:31], s99 offen offset:0 nt
    ds_read_b32 v23, v22 offset:10368
    v_add_u32 v114, s60, v113
    ds_read_b64 v[116:117], v114 offset:11392
    s_waitcnt vmcnt(4)
    buffer_load_dwordx4 v[108:111], v112, s[28:31], s99 offen offset:256 nt
L_tk0:
    s_waitcnt lgkmcnt(0)
    v_readfirstlane_b32 s96, v23
    s_nop 0
    s_cmp_eq_u32 s96, 0
    s_cbranch_scc1 L_tkw0
    v_add_u32 v22, 4, v22
    s_and_b32 s58, s96, 0x00fe0e00
    s_add_u32 s58, s58, s74
    s_add_u32 s99, s58, 4096
    s_bitcmp1_b32 s96, 1
    s_cselect_b64 s[28:29], s[6:7], s[4:5]
    s_cselect_b64 s[80:81], -1, 0
    v_cndmask_b32 v112, v8, v9, s[80:81]
    s_lshr_b32 s60, s98, 24
    s_lshl_b32 s60, s60, 6
    s_bitcmp1_b32 s97, 1
    s_cbranch_scc1 L_V1
    s_waitcnt vmcnt(4)
    buffer_load_dwordx4 v[64:67], v112, s[28:31], s58 offen offset:0 nt
    ds_write_b32 v2, v22 offset:10320
    v_mfma_f32_16x16x32_bf16 v[24:27], v[80:83], v[12:15], 0
    v_mfma_f32_16x16x32_bf16 v[28:31], v[84:87], v[12:15], 0
    v_mfma_f32_16x16x32_bf16 v[32:35], v[88:91], v[12:15], 0
    v_mfma_f32_16x16x32_bf16 v[36:39], v[92:95], v[12:15], 0
    s_waitcnt vmcnt(4)
    buffer_load_dwordx4 v[68:71], v112, s[28:31], s58 offen offset:256 nt
    s_nop 2
    v_mov_b32_dpp v40, v24 quad_perm:[0,0,0,0] row_mask:0xf bank_mask:0xf
    v_mov_b32_dpp v41, v28 quad_perm:[0,0,0,0] row_mask:0xf bank_mask:0xf
    v_mov_b32_dpp v42, v32 quad_perm:[0,0,0,0] row_mask:0xf bank_mask:0xf
    v_mov_b32_dpp v43, v36 quad_perm:[0,0,0,0] row_mask:0xf bank_mask:0xf
    v_add_f32_dpp v40, v25, v40 quad_perm:[1,1,1,1] row_mask:0xf bank_mask:0xf
    v_add_f32_dpp v41, v29, v41 quad_perm:[1,1,1,1] row_mask:0xf bank_mask:0xf
    v_add_f32_dpp v42, v33, v42 quad_perm:[1,1,1,1] row_mask:0xf bank_mask:0xf
    v_add_f32_dpp v43, v37, v43 quad_perm:[1,1,1,1] row_mask:0xf bank_mask:0xf
    v_add_f32_dpp v40, v26, v40 quad_perm:[2,2,2,2] row_mask:0xf bank_mask:0xf
    v_add_f32_dpp v41, v30, v41 quad_perm:[2,2,2,2] row_mask:0xf bank_mask:0xf
    v_add_f32_dpp v42, v34, v42 quad_perm:[2,2,2,2] row_mask:0xf bank_mask:0xf
    v_add_f32_dpp v43, v38, v43 quad_perm:[2,2,2,2] row_mask:0xf bank_mask:0xf
    v_add_f32_dpp v40, v27, v40 quad_perm:[3,3,3,3] row_mask:0xf bank_mask:0xf
    v_add_f32_dpp v41, v31, v41 quad_perm:[3,3,3,3] row_mask:0xf bank_mask:0xf
    v_add_f32_dpp v42, v35, v42 quad_perm:[3,3,3,3] row_mask:0xf bank_mask:0xf
    v_add_f32_dpp v43, v39, v43 quad_perm:[3,3,3,3] row_mask:0xf bank_mask:0xf
    s_waitcnt vmcnt(4)
    buffer_load_dwordx4 v[72:75], v112, s[28:31], s99 offen offset:0 nt
    ds_read_b32 v23, v22 offset:10368
    v_cvt_pk_bf16_f32 v44, v40, v41
    v_cvt_pk_bf16_f32 v45, v42, v43
    v_lshlrev_b32 v40, 16, v44
    v_and_b32 v41, 0xffff0000, v44
    v_lshlrev_b32 v42, 16, v45
    v_and_b32 v43, 0xffff0000, v45
    v_mul_f32 v40, s63, v40
    v_mul_f32 v41, s63, v41
    v_mul_f32 v42, s63, v42
    v_mul_f32 v43, s63, v43
    v_cvt_pk_bf16_f32 v44, v40, v41
    v_cvt_pk_bf16_f32 v45, v42, v43
    ds_write_b64 v114, v[44:45] offset:11392
    v_add_u32 v114, s60, v113
    ds_read_b64 v[116:117], v114 offset:11392
    s_waitcnt vmcnt(4)
    buffer_load_dwordx4 v[76:79], v112, s[28:31], s99 offen offset:256 nt
    s_branch L_tk1
L_V1:
    s_waitcnt vmcnt(4)
    buffer_load_dwordx4 v[64:67], v112, s[28:31], s58 offen offset:0 nt
    ds_write_b32 v2, v22 offset:10320
    v_lshlrev_b32 v40, 16, v116
    v_and_b32 v41, 0xffff0000, v116
    v_lshlrev_b32 v42, 16, v117
    v_and_b32 v43, 0xffff0000, v117
    v_max3_f32 v46, v40, v41, v42
    v_max_f32 v46, v46, v43
    v_cmp_gt_f32 vcc, v46, v10
    s_cbranch_vccnz L_resc1
L_back1:
    v_fma_f32 v40, v40, s64, v11
    v_fma_f32 v41, v41, s64, v11
    v_fma_f32 v42, v42, s64, v11
    v_fma_f32 v43, v43, s64, v11
    v_exp_f32 v40, v40
    v_exp_f32 v41, v41
    v_exp_f32 v42, v42
    v_exp_f32 v43, v43
    v_add_f32 v46, v40, v41
    v_add_f32 v47, v42, v43
    v_cvt_pk_bf16_f32 v40, v40, v40
    v_cvt_pk_bf16_f32 v41, v41, v41
    v_cvt_pk_bf16_f32 v42, v42, v42
    v_cvt_pk_bf16_f32 v43, v43, v43
    v_add_f32 v46, v46, v47
    v_add_f32 v20, v20, v46
    v_and_b32 v48, v40, v4
    v_and_b32 v49, v40, v5
    v_and_b32 v50, v40, v6
    v_and_b32 v51, v40, v7
    v_and_b32 v52, v41, v4
    v_and_b32 v53, v41, v5
    v_and_b32 v54, v41, v6
    v_and_b32 v55, v41, v7
    v_and_b32 v56, v42, v4
    v_and_b32 v57, v42, v5
    v_and_b32 v58, v42, v6
    v_and_b32 v59, v42, v7
    v_and_b32 v60, v43, v4
    v_and_b32 v61, v43, v5
    v_and_b32 v62, v43, v6
    v_and_b32 v63, v43, v7
    s_waitcnt vmcnt(4)
    buffer_load_dwordx4 v[68:71], v112, s[28:31], s58 offen offset:256 nt
    v_mfma_f32_16x16x32_bf16 v[16:19], v[48:51], v[80:83], v[16:19]
    v_mfma_f32_16x16x32_bf16 v[16:19], v[52:55], v[84:87], v[16:19]
    v_mfma_f32_16x16x32_bf16 v[16:19], v[56:59], v[88:91], v[16:19]
    v_mfma_f32_16x16x32_bf16 v[16:19], v[60:63], v[92:95], v[16:19]
    s_bitcmp1_b32 s98, 23
    s_cbranch_scc1 L_loop_done
    s_waitcnt vmcnt(4)
    buffer_load_dwordx4 v[72:75], v112, s[28:31], s99 offen offset:0 nt
    ds_read_b32 v23, v22 offset:10368
    v_add_u32 v114, s60, v113
    ds_read_b64 v[116:117], v114 offset:11392
    s_waitcnt vmcnt(4)
    buffer_load_dwordx4 v[76:79], v112, s[28:31], s99 offen offset:256 nt
L_tk1:
    s_waitcnt lgkmcnt(0)
    v_readfirstlane_b32 s97, v23
    s_nop 0
    s_cmp_eq_u32 s97, 0
    s_cbranch_scc1 L_tkw1
    v_add_u32 v22, 4, v22
    s_and_b32 s58, s97, 0x00fe0e00
    s_add_u32 s58, s58, s74
    s_add_u32 s99, s58, 4096
    s_bitcmp1_b32 s97, 1
    s_cselect_b64 s[28:29], s[6:7], s[4:5]
    s_cselect_b64 s[80:81], -1, 0
    v_cndmask_b32 v112, v8, v9, s[80:81]
    s_lshr_b32 s60, s96, 24
    s_lshl_b32 s60, s60, 6
    s_bitcmp1_b32 s98, 1
    s_cbranch_scc1 L_V2
    s_waitcnt vmcnt(4)
    buffer_load_dwordx4 v[80:83], v112, s[28:31], s58 offen offset:0 nt
    ds_write_b32 v2, v22 offset:10320
    v_mfma_f32_16x16x32_bf16 v[24:27], v[96:99], v[12:15], 0
    v_mfma_f32_16x16x32_bf16 v[28:31], v[100:103], v[12:15], 0
    v_mfma_f32_16x16x32_bf16 v[32:35], v[104:107], v[12:15], 0
    v_mfma_f32_16x16x32_bf16 v[36:39], v[108:111], v[12:15], 0
    s_waitcnt vmcnt(4)
    buffer_load_dwordx4 v[84:87], v112, s[28:31], s58 offen offset:256 nt
    s_nop 2
    v_mov_b32_dpp v40, v24 quad_perm:[0,0,0,0] row_mask:0xf bank_mask:0xf
    v_mov_b32_dpp v41, v28 quad_perm:[0,0,0,0] row_mask:0xf bank_mask:0xf
    v_mov_b32_dpp v42, v32 quad_perm:[0,0,0,0] row_mask:0xf bank_mask:0xf
    v_mov_b32_dpp v43, v36 quad_perm:[0,0,0,0] row_mask:0xf bank_mask:0xf
    v_add_f32_dpp v40, v25, v40 quad_perm:[1,1,1,1] row_mask:0xf bank_mask:0xf
    v_add_f32_dpp v41, v29, v41 quad_perm:[1,1,1,1] row_mask:0xf bank_mask:0xf
    v_add_f32_dpp v42, v33, v42 quad_perm:[1,1,1,1] row_mask:0xf bank_mask:0xf
    v_add_f32_dpp v43, v37, v43 quad_perm:[1,1,1,1] row_mask:0xf bank_mask:0xf
    v_add_f32_dpp v40, v26, v40 quad_perm:[2,2,2,2] row_mask:0xf bank_mask:0xf
    v_add_f32_dpp v41, v30, v41 quad_perm:[2,2,2,2] row_mask:0xf bank_mask:0xf
    v_add_f32_dpp v42, v34, v42 quad_perm:[2,2,2,2] row_mask:0xf bank_mask:0xf
    v_add_f32_dpp v43, v38, v43 quad_perm:[2,2,2,2] row_mask:0xf bank_mask:0xf
    v_add_f32_dpp v40, v27, v40 quad_perm:[3,3,3,3] row_mask:0xf bank_mask:0xf
    v_add_f32_dpp v41, v31, v41 quad_perm:[3,3,3,3] row_mask:0xf bank_mask:0xf
    v_add_f32_dpp v42, v35, v42 quad_perm:[3,3,3,3] row_mask:0xf bank_mask:0xf
    v_add_f32_dpp v43, v39, v43 quad_perm:[3,3,3,3] row_mask:0xf bank_mask:0xf
    s_waitcnt vmcnt(4)
    buffer_load_dwordx4 v[88:91], v112, s[28:31], s99 offen offset:0 nt
    ds_read_b32 v23, v22 offset:10368
    v_cvt_pk_bf16_f32 v44, v40, v41
    v_cvt_pk_bf16_f32 v45, v42, v43
    v_lshlrev_b32 v40, 16, v44
    v_and_b32 v41, 0xffff0000, v44
    v_lshlrev_b32 v42, 16, v45
    v_and_b32 v43, 0xffff0000, v45
    v_mul_f32 v40, s63, v40
    v_mul_f32 v41, s63, v41
    v_mul_f32 v42, s63, v42
    v_mul_f32 v43, s63, v43
    v_cvt_pk_bf16_f32 v44, v40, v41
    v_cvt_pk_bf16_f32 v45, v42, v43
    ds_write_b64 v114, v[44:45] offset:11392
    v_add_u32 v114, s60, v113
    ds_read_b64 v[116:117], v114 offset:11392
    s_waitcnt vmcnt(4)
    buffer_load_dwordx4 v[92:95], v112, s[28:31], s99 offen offset:256 nt
    s_branch L_tk2
L_V2:
    s_waitcnt vmcnt(4)
    buffer_load_dwordx4 v[80:83], v112, s[28:31], s58 offen offset:0 nt
    ds_write_b32 v2, v22 offset:10320
    v_lshlrev_b32 v40, 16, v116
    v_and_b32 v41, 0xffff0000, v116
    v_lshlrev_b32 v42, 16, v117
    v_and_b32 v43, 0xffff0000, v117
    v_max3_f32 v46, v40, v41, v42
    v_max_f32 v46, v46, v43
    v_cmp_gt_f32 vcc, v46, v10
    s_cbranch_vccnz L_resc2
L_back2:
    v_fma_f32 v40, v40, s64, v11
    v_fma_f32 v41, v41, s64, v11
    v_fma_f32 v42, v42, s64, v11
    v_fma_f32 v43, v43, s64, v11
    v_exp_f32 v40, v40
    v_exp_f32 v41, v41
    v_exp_f32 v42, v42
    v_exp_f32 v43, v43
    v_add_f32 v46, v40, v41
    v_add_f32 v47, v42, v43
    v_cvt_pk_bf16_f32 v40, v40, v40
    v_cvt_pk_bf16_f32 v41, v41, v41
    v_cvt_pk_bf16_f32 v42, v42, v42
    v_cvt_pk_bf16_f32 v43, v43, v43
    v_add_f32 v46, v46, v47
    v_add_f32 v20, v20, v46
    v_and_b32 v48, v40, v4
    v_and_b32 v49, v40, v5
    v_and_b32 v50, v40, v6
    v_and_b32 v51, v40, v7
    v_and_b32 v52, v41, v4
    v_and_b32 v53, v41, v5
    v_and_b32 v54, v41, v6
    v_and_b32 v55, v41, v7
    v_and_b32 v56, v42, v4
    v_and_b32 v57, v42, v5
    v_and_b32 v58, v42, v6
    v_and_b32 v59, v42, v7
    v_and_b32 v60, v43, v4
    v_and_b32 v61, v43, v5
    v_and_b32 v62, v43, v6
    v_and_b32 v63, v43, v7
    s_waitcnt vmcnt(4)
    buffer_load_dwordx4 v[84:87], v112, s[28:31], s58 offen offset:256 nt
    v_mfma_f32_16x16x32_bf16 v[16:19], v[48:51], v[96:99], v[16:19]
    v_mfma_f32_16x16x32_bf16 v[16:19], v[52:55], v[100:103], v[16:19]
    v_mfma_f32_16x16x32_bf16 v[16:19], v[56:59], v[104:107], v[16:19]
    v_mfma_f32_16x16x32_bf16 v[16:19], v[60:63], v[108:111], v[16:19]
    s_bitcmp1_b32 s96, 23
    s_cbranch_scc1 L_loop_done
    s_waitcnt vmcnt(4)
    buffer_load_dwordx4 v[88:91], v112, s[28:31], s99 offen offset:0 nt
    ds_read_b32 v23, v22 offset:10368
    v_add_u32 v114, s60, v113
    ds_read_b64 v[116:117], v114 offset:11392
    s_waitcnt vmcnt(4)
    buffer_load_dwordx4 v[92:95], v112, s[28:31], s99 offen offset:256 nt
L_tk2:
    s_waitcnt lgkmcnt(0)
    v_readfirstlane_b32 s98, v23
    s_nop 0
    s_cmp_eq_u32 s98, 0
    s_cbranch_scc1 L_tkw2
    v_add_u32 v22, 4, v22
    s_branch L_loop
L_tkw0:
    s_sub_u32 s66, s66, 1
    s_cmp_le_i32 s66, 0
    s_cbranch_scc1 L_loop_done
    ds_read_b32 v23, v22 offset:10368
    s_branch L_tk0
L_tkw1:
    s_sub_u32 s66, s66, 1
    s_cmp_le_i32 s66, 0
    s_cbranch_scc1 L_loop_done
    ds_read_b32 v23, v22 offset:10368
    s_branch L_tk1
L_tkw2:
    s_sub_u32 s66, s66, 1
    s_cmp_le_i32 s66, 0
    s_cbranch_scc1 L_loop_done
    ds_read_b32 v23, v22 offset:10368
    s_branch L_tk2
L_resc0:
    v_max_f32 v46, v46, v10
    v_mov_b32 v47, v46
    s_nop 1
    v_permlane16_swap_b32 v46, v47
    v_max_f32 v46, v46, v47
    v_mov_b32 v47, v46
    s_nop 1
    v_permlane32_swap_b32 v46, v47
    v_max_f32 v46, v46, v47
    v_sub_f32 v47, v10, v46
    v_mul_f32 v47, s64, v47
    v_exp_f32 v47, v47
    v_mov_b32 v10, v46
    v_mul_f32 v11, s65, v46
    v_mul_f32 v20, v20, v47
    v_readlane_b32 s72, v47, 0
    v_readlane_b32 s73, v47, 8
    s_nop 0
    v_mov_b32 v46, s72
    v_mov_b32 v47, s73
    v_cndmask_b32 v46, v46, v47, s[68:69]
    v_mul_f32 v16, v16, v46
    v_mul_f32 v17, v17, v46
    v_mul_f32 v18, v18, v46
    v_mul_f32 v19, v19, v46
    s_branch L_back0
L_resc1:
    v_max_f32 v46, v46, v10
    v_mov_b32 v47, v46
    s_nop 1
    v_permlane16_swap_b32 v46, v47
    v_max_f32 v46, v46, v47
    v_mov_b32 v47, v46
    s_nop 1
    v_permlane32_swap_b32 v46, v47
    v_max_f32 v46, v46, v47
    v_sub_f32 v47, v10, v46
    v_mul_f32 v47, s64, v47
    v_exp_f32 v47, v47
    v_mov_b32 v10, v46
    v_mul_f32 v11, s65, v46
    v_mul_f32 v20, v20, v47
    v_readlane_b32 s72, v47, 0
    v_readlane_b32 s73, v47, 8
    s_nop 0
    v_mov_b32 v46, s72
    v_mov_b32 v47, s73
    v_cndmask_b32 v46, v46, v47, s[68:69]
    v_mul_f32 v16, v16, v46
    v_mul_f32 v17, v17, v46
    v_mul_f32 v18, v18, v46
    v_mul_f32 v19, v19, v46
    s_branch L_back1
L_resc2:
    v_max_f32 v46, v46, v10
    v_mov_b32 v47, v46
    s_nop 1
    v_permlane16_swap_b32 v46, v47
    v_max_f32 v46, v46, v47
    v_mov_b32 v47, v46
    s_nop 1
    v_permlane32_swap_b32 v46, v47
    v_max_f32 v46, v46, v47
    v_sub_f32 v47, v10, v46
    v_mul_f32 v47, s64, v47
    v_exp_f32 v47, v47
    v_mov_b32 v10, v46
    v_mul_f32 v11, s65, v46
    v_mul_f32 v20, v20, v47
    v_readlane_b32 s72, v47, 0
    v_readlane_b32 s73, v47, 8
    s_nop 0
    v_mov_b32 v46, s72
    v_mov_b32 v47, s73
    v_cndmask_b32 v46, v46, v47, s[68:69]
    v_mul_f32 v16, v16, v46
    v_mul_f32 v17, v17, v46
    v_mul_f32 v18, v18, v46
    v_mul_f32 v19, v19, v46
    s_branch L_back2
L_loop_done:
    v_mov_b32 v46, v20
    s_nop 1
    v_permlane16_swap_b32 v20, v46
    v_add_f32 v20, v20, v46
    v_mov_b32 v46, v20
    s_nop 1
    v_permlane32_swap_b32 v20, v46
    v_add_f32 v20, v20, v46
    ds_write_b128 v3, v[16:19] offset:6144
    v_mov_b32 v11, v20
    ds_write_b64 v21, v[10:11] offset:10240
    s_waitcnt lgkmcnt(0)
    s_barrier
    s_cmp_lg_u32 s67, 0
    s_cbranch_scc1 L_att_nopub
    ds_read_b64 v[44:45], v1 offset:10240
    ds_read_b64 v[46:47], v1 offset:10256
    ds_read_b64 v[48:49], v1 offset:10272
    ds_read_b64 v[50:51], v1 offset:10288
    ds_read_b128 v[24:27], v115 offset:6144
    ds_read_b128 v[28:31], v115 offset:7168
    ds_read_b128 v[32:35], v115 offset:8192
    ds_read_b128 v[36:39], v115 offset:9216
    s_waitcnt lgkmcnt(4)
    v_max3_f32 v56, v44, v46, v48
    v_max_f32 v56, v56, v50
    v_sub_f32 v44, v44, v56
    v_sub_f32 v46, v46, v56
    v_sub_f32 v48, v48, v56
    v_sub_f32 v50, v50, v56
    v_mul_f32 v44, s64, v44
    v_mul_f32 v46, s64, v46
    v_mul_f32 v48, s64, v48
    v_mul_f32 v50, s64, v50
    v_exp_f32 v44, v44
    v_exp_f32 v46, v46
    v_exp_f32 v48, v48
    v_exp_f32 v50, v50
    v_mov_b32 v58, v56
    v_mul_f32 v57, v45, v44
    v_fmac_f32 v57, v47, v46
    v_fmac_f32 v57, v49, v48
    v_fmac_f32 v57, v51, v50
    v_permlane32_swap_b32 v56, v58
    v_mov_b32 v59, v57
    s_waitcnt lgkmcnt(0)
    v_mul_f32 v24, v24, v44
    v_mul_f32 v25, v25, v44
    v_mul_f32 v26, v26, v44
    v_mul_f32 v27, v27, v44
    v_permlane32_swap_b32 v57, v59
    v_fmac_f32 v24, v28, v46
    v_fmac_f32 v25, v29, v46
    v_fmac_f32 v26, v30, v46
    v_fmac_f32 v27, v31, v46
    v_fmac_f32 v24, v32, v48
    v_fmac_f32 v25, v33, v48
    v_fmac_f32 v26, v34, v48
    v_fmac_f32 v27, v35, v48
    v_fmac_f32 v24, v36, v50
    v_fmac_f32 v25, v37, v50
    v_fmac_f32 v26, v38, v50
    v_fmac_f32 v27, v39, v50
    v_bfi_b32 v56, 15, s76, v56
    v_bfi_b32 v57, 15, s77, v57
    v_bfi_b32 v58, 15, s78, v58
    v_bfi_b32 v59, 15, s79, v59
    v_bfi_b32 v24, 15, s76, v24
    v_bfi_b32 v25, 15, s77, v25
    v_bfi_b32 v26, 15, s78, v26
    v_bfi_b32 v27, 15, s79, v27
    buffer_store_dwordx4 v[24:27], v123, s[36:39], s82 offen sc1
    s_mov_b64 exec, 0xff
    buffer_store_dwordx4 v[56:59], v115, s[36:39], s83 offen sc1
    s_mov_b64 exec, -1
L_att_nopub:
    s_bitcmp0_b32 s56, 0
    s_cbranch_scc1 L_end
    s_mov_b32 s58, 0
    buffer_load_dwordx4 v[128:131], v119, s[32:35], s58 offen nt
    s_add_u32 s58, s58, 4608
    buffer_load_dwordx4 v[132:135], v119, s[32:35], s58 offen nt
    s_add_u32 s58, s58, 4608
    buffer_load_dwordx4 v[136:139], v119, s[32:35], s58 offen nt
    s_add_u32 s58, s58, 4608
    buffer_load_dwordx4 v[140:143], v119, s[32:35], s58 offen nt
    s_add_u32 s58, s58, 4608
    buffer_load_dwordx4 v[144:147], v119, s[32:35], s58 offen nt
    s_add_u32 s58, s58, 4608
    buffer_load_dwordx4 v[148:151], v119, s[32:35], s58 offen nt
    s_add_u32 s58, s58, 4608
    buffer_load_dwordx4 v[152:155], v119, s[32:35], s58 offen nt
    s_add_u32 s58, s58, 4608
    buffer_load_dwordx4 v[156:159], v119, s[32:35], s58 offen nt
    s_add_u32 s58, s58, 4608
    buffer_load_dwordx4 v[160:163], v119, s[32:35], s58 offen nt
    s_add_u32 s58, s58, 4608
    buffer_load_dwordx4 v[164:167], v119, s[32:35], s58 offen nt
    s_add_u32 s58, s58, 4608
    buffer_load_dwordx4 v[168:171], v119, s[32:35], s58 offen nt
    s_add_u32 s58, s58, 4608
    buffer_load_dwordx4 v[172:175], v119, s[32:35], s58 offen nt
    s_add_u32 s58, s58, 4608
    buffer_load_dwordx4 v[176:179], v119, s[32:35], s58 offen nt
    s_add_u32 s58, s58, 4608
    buffer_load_dwordx4 v[180:183], v119, s[32:35], s58 offen nt
    s_add_u32 s58, s58, 4608
    buffer_load_dwordx4 v[184:187], v119, s[32:35], s58 offen nt
    s_add_u32 s58, s58, 4608
    buffer_load_dwordx4 v[188:191], v119, s[32:35], s58 offen nt
    s_cmp_lg_u32 s67, 3
    s_cbranch_scc1 L_notail
    v_lshrrev_b32 v8, 4, v0
    v_bfe_u32 v9, v0, 3, 1
    v_lshl_add_u32 v8, v9, 2, v8
    v_mul_u32_u24 v8, 1152, v8
    v_and_b32 v9, 7, v0
    v_lshl_add_u32 v8, v9, 4, v8
    s_mov_b32 s58, 1024
    buffer_load_dwordx4 v[192:195], v8, s[32:35], s58 offen nt
    s_add_u32 s58, s58, 9216
    buffer_load_dwordx4 v[196:199], v8, s[32:35], s58 offen nt
    s_add_u32 s58, s58, 9216
    buffer_load_dwordx4 v[200:203], v8, s[32:35], s58 offen nt
    s_add_u32 s58, s58, 9216
    buffer_load_dwordx4 v[204:207], v8, s[32:35], s58 offen nt
    s_add_u32 s58, s58, 9216
    buffer_load_dwordx4 v[208:211], v8, s[32:35], s58 offen nt
    s_add_u32 s58, s58, 9216
    buffer_load_dwordx4 v[212:215], v8, s[32:35], s58 offen nt
    s_add_u32 s58, s58, 9216
    buffer_load_dwordx4 v[216:219], v8, s[32:35], s58 offen nt
    s_add_u32 s58, s58, 9216
    buffer_load_dwordx4 v[220:223], v8, s[32:35], s58 offen nt
    v_mov_b32 v56, 0
    v_mov_b32 v57, 0
    v_mov_b32 v58, 0
    v_mov_b32 v59, 0
    v_mov_b32 v60, 0
    v_mov_b32 v61, 0
    v_mov_b32 v62, 0
    v_mov_b32 v63, 0
L_notail:
    v_mov_b32 v16, 0
    v_mov_b32 v17, 0
    v_mov_b32 v18, 0
    v_mov_b32 v19, 0
    s_cmp_lg_u32 s56, 1
    s_cbranch_scc1 L_owner
    s_waitcnt vmcnt(0)
    s_branch L_proj
L_owner:
    s_lshr_b32 s61, s67, 1
    s_lshl_b32 s62, s52, 1
    s_add_u32 s62, s62, s61
    s_lshl_b32 s58, s62, 12
    s_and_b32 s59, s67, 1
    s_and_b32 s60, s57, 1
    s_lshl_b32 s72, s60, 1
    s_add_u32 s72, s72, s59
    s_lshl_b32 s72, s72, 7
    s_add_u32 s58, s58, s72
    s_add_u32 s58, s58, 393216
    s_lshl_b32 s62, s61, 4
    s_lshr_b32 s72, s52, 1
    s_add_u32 s62, s62, s72
    s_lshl_b32 s62, s62, 10
    s_add_u32 s62, s62, 655360
    s_and_b32 s72, s52, 1
    s_cselect_b64 s[80:81], -1, 0
L_own_poll:
    buffer_load_dwordx4 v[28:31], v115, s[36:39], s62 offen sc1
    buffer_load_dwordx4 v[24:27], v121, s[36:39], s58 offen sc1
    s_waitcnt vmcnt(0)
    v_xor_b32 v32, s76, v24
    v_xor_b32 v33, s77, v25
    v_bitop3_b32 v32, v26, s78, v32 bitop3:0xbe
    v_bitop3_b32 v33, v27, s79, v33 bitop3:0xbe
    v_bitop3_b32 v32, v28, s76, v32 bitop3:0xbe
    v_bitop3_b32 v33, v29, s77, v33 bitop3:0xbe
    v_bitop3_b32 v32, v30, s78, v32 bitop3:0xbe
    v_bitop3_b32 v33, v31, s79, v33 bitop3:0xbe
    v_bitop3_b32 v32, v32, v33, 15 bitop3:0xa8
    v_cmp_ne_u32 vcc, 0, v32
    s_cbranch_vccz L_own_ok
    s_sub_u32 s66, s66, 1
    s_cmp_gt_i32 s66, 0
    s_cbranch_scc1 L_own_poll
L_own_ok:
    v_cndmask_b32 v28, v28, v30, s[80:81]
    v_cndmask_b32 v29, v29, v31, s[80:81]
    s_nop 0
    v_max_f32_dpp v30, v28, v28 row_ror:8 row_mask:0xf bank_mask:0xf
    v_mov_b32 v31, v30
    s_nop 1
    v_permlane16_swap_b32 v30, v31
    v_max_f32 v30, v30, v31
    v_mov_b32 v31, v30
    s_nop 1
    v_permlane32_swap_b32 v30, v31
    v_max_f32 v30, v30, v31
    v_sub_f32 v28, v28, v30
    v_mul_f32 v28, s64, v28
    v_exp_f32 v28, v28
    s_nop 0
    v_mul_f32 v29, v29, v28
    v_mul_f32 v24, v24, v28
    v_mul_f32 v25, v25, v28
    v_mul_f32 v26, v26, v28
    v_mul_f32 v27, v27, v28
    v_add_f32_dpp v29, v29, v29 row_ror:8 row_mask:0xf bank_mask:0xf
    v_permlane32_swap_b32 v24, v26
    v_permlane32_swap_b32 v25, v27
    v_mov_b32 v31, v29
    v_add_f32 v24, v24, v26
    v_add_f32 v25, v25, v27
    v_permlane16_swap_b32 v29, v31
    v_add_f32 v29, v29, v31
    v_permlane16_swap_b32 v24, v25
    v_mov_b32 v31, v29
    v_add_f32 v24, v24, v25
    s_nop 0
    v_permlane32_swap_b32 v29, v31
    v_add_f32 v29, v29, v31
    v_add_f32_dpp v24, v24, v24 row_ror:8 row_mask:0xf bank_mask:0xf
    v_rcp_f32 v29, v29
    s_nop 0
    v_mul_f32 v24, v24, v29
    v_cvt_pk_bf16_f32 v24, v24, v24
    ds_write_b32 v122, v24 offset:5120
    s_waitcnt lgkmcnt(0)
    s_barrier
L_proj:
    ds_read_b128 v[24:27], v120 offset:5120
    ds_read_b128 v[28:31], v120 offset:5136
    ds_read_b128 v[32:35], v120 offset:5152
    ds_read_b128 v[36:39], v120 offset:5168
    s_cmp_eq_u32 s67, 3
    s_cbranch_scc1 L_proj3
    s_waitcnt lgkmcnt(3)
    v_and_b32 v40, v24, v4
    v_and_b32 v41, v24, v5
    v_and_b32 v42, v24, v6
    v_and_b32 v43, v24, v7
    v_and_b32 v44, v25, v4
    v_and_b32 v45, v25, v5
    v_and_b32 v46, v25, v6
    v_and_b32 v47, v25, v7
    v_mfma_f32_16x16x32_bf16 v[16:19], v[40:43], v[128:131], v[16:19]
    v_and_b32 v48, v26, v4
    v_and_b32 v49, v26, v5
    v_and_b32 v50, v26, v6
    v_and_b32 v51, v26, v7
    v_mfma_f32_16x16x32_bf16 v[16:19], v[44:47], v[132:135], v[16:19]
    v_and_b32 v52, v27, v4
    v_and_b32 v53, v27, v5
    v_and_b32 v54, v27, v6
    v_and_b32 v55, v27, v7
    v_mfma_f32_16x16x32_bf16 v[16:19], v[48:51], v[136:139], v[16:19]
    s_waitcnt lgkmcnt(2)
    v_and_b32 v40, v28, v4
    v_and_b32 v41, v28, v5
    v_and_b32 v42, v28, v6
    v_and_b32 v43, v28, v7
    v_mfma_f32_16x16x32_bf16 v[16:19], v[52:55], v[140:143], v[16:19]
    v_and_b32 v44, v29, v4
    v_and_b32 v45, v29, v5
    v_and_b32 v46, v29, v6
    v_and_b32 v47, v29, v7
    v_mfma_f32_16x16x32_bf16 v[16:19], v[40:43], v[144:147], v[16:19]
    v_and_b32 v48, v30, v4
    v_and_b32 v49, v30, v5
    v_and_b32 v50, v30, v6
    v_and_b32 v51, v30, v7
    v_mfma_f32_16x16x32_bf16 v[16:19], v[44:47], v[148:151], v[16:19]
    v_and_b32 v52, v31, v4
    v_and_b32 v53, v31, v5
    v_and_b32 v54, v31, v6
    v_and_b32 v55, v31, v7
    v_mfma_f32_16x16x32_bf16 v[16:19], v[48:51], v[152:155], v[16:19]
    s_waitcnt lgkmcnt(1)
    v_and_b32 v40, v32, v4
    v_and_b32 v41, v32, v5
    v_and_b32 v42, v32, v6
    v_and_b32 v43, v32, v7
    v_mfma_f32_16x16x32_bf16 v[16:19], v[52:55], v[156:159], v[16:19]
    v_and_b32 v44, v33, v4
    v_and_b32 v45, v33, v5
    v_and_b32 v46, v33, v6
    v_and_b32 v47, v33, v7
    v_mfma_f32_16x16x32_bf16 v[16:19], v[40:43], v[160:163], v[16:19]
    v_and_b32 v48, v34, v4
    v_and_b32 v49, v34, v5
    v_and_b32 v50, v34, v6
    v_and_b32 v51, v34, v7
    v_mfma_f32_16x16x32_bf16 v[16:19], v[44:47], v[164:167], v[16:19]
    v_and_b32 v52, v35, v4
    v_and_b32 v53, v35, v5
    v_and_b32 v54, v35, v6
    v_and_b32 v55, v35, v7
    v_mfma_f32_16x16x32_bf16 v[16:19], v[48:51], v[168:171], v[16:19]
    s_waitcnt lgkmcnt(0)
    v_and_b32 v40, v36, v4
    v_and_b32 v41, v36, v5
    v_and_b32 v42, v36, v6
    v_and_b32 v43, v36, v7
    v_mfma_f32_16x16x32_bf16 v[16:19], v[52:55], v[172:175], v[16:19]
    v_and_b32 v44, v37, v4
    v_and_b32 v45, v37, v5
    v_and_b32 v46, v37, v6
    v_and_b32 v47, v37, v7
    v_mfma_f32_16x16x32_bf16 v[16:19], v[40:43], v[176:179], v[16:19]
    v_and_b32 v48, v38, v4
    v_and_b32 v49, v38, v5
    v_and_b32 v50, v38, v6
    v_and_b32 v51, v38, v7
    v_mfma_f32_16x16x32_bf16 v[16:19], v[44:47], v[180:183], v[16:19]
    v_and_b32 v52, v39, v4
    v_and_b32 v53, v39, v5
    v_and_b32 v54, v39, v6
    v_and_b32 v55, v39, v7
    v_mfma_f32_16x16x32_bf16 v[16:19], v[48:51], v[184:187], v[16:19]
    s_nop 0
    v_mfma_f32_16x16x32_bf16 v[16:19], v[52:55], v[188:191], v[16:19]
    s_nop 7
    v_bfi_b32 v16, 15, s76, v16
    v_bfi_b32 v17, 15, s77, v17
    v_bfi_b32 v18, 15, s78, v18
    v_bfi_b32 v19, 15, s79, v19
    buffer_store_dwordx4 v[16:19], v118, s[36:39], s14 offen sc1
    s_endpgm
L_proj3:
    s_waitcnt lgkmcnt(3)
    v_and_b32 v40, v24, v4
    v_and_b32 v41, v24, v5
    v_and_b32 v42, v24, v6
    v_and_b32 v43, v24, v7
    v_and_b32 v44, v25, v4
    v_and_b32 v45, v25, v5
    v_and_b32 v46, v25, v6
    v_and_b32 v47, v25, v7
    v_mfma_f32_16x16x32_bf16 v[16:19], v[40:43], v[128:131], v[16:19]
    v_mfma_f32_16x16x32_bf16 v[56:59], v[40:43], v[192:195], v[56:59]
    v_and_b32 v48, v26, v4
    v_and_b32 v49, v26, v5
    v_and_b32 v50, v26, v6
    v_and_b32 v51, v26, v7
    v_mfma_f32_16x16x32_bf16 v[16:19], v[44:47], v[132:135], v[16:19]
    v_mfma_f32_16x16x32_bf16 v[60:63], v[44:47], v[192:195], v[60:63]
    v_and_b32 v52, v27, v4
    v_and_b32 v53, v27, v5
    v_and_b32 v54, v27, v6
    v_and_b32 v55, v27, v7
    v_mfma_f32_16x16x32_bf16 v[16:19], v[48:51], v[136:139], v[16:19]
    v_mfma_f32_16x16x32_bf16 v[56:59], v[48:51], v[196:199], v[56:59]
    s_waitcnt lgkmcnt(2)
    v_and_b32 v40, v28, v4
    v_and_b32 v41, v28, v5
    v_and_b32 v42, v28, v6
    v_and_b32 v43, v28, v7
    v_mfma_f32_16x16x32_bf16 v[16:19], v[52:55], v[140:143], v[16:19]
    v_mfma_f32_16x16x32_bf16 v[60:63], v[52:55], v[196:199], v[60:63]
    v_and_b32 v44, v29, v4
    v_and_b32 v45, v29, v5
    v_and_b32 v46, v29, v6
    v_and_b32 v47, v29, v7
    v_mfma_f32_16x16x32_bf16 v[16:19], v[40:43], v[144:147], v[16:19]
    v_mfma_f32_16x16x32_bf16 v[56:59], v[40:43], v[200:203], v[56:59]
    v_and_b32 v48, v30, v4
    v_and_b32 v49, v30, v5
    v_and_b32 v50, v30, v6
    v_and_b32 v51, v30, v7
    v_mfma_f32_16x16x32_bf16 v[16:19], v[44:47], v[148:151], v[16:19]
    v_mfma_f32_16x16x32_bf16 v[60:63], v[44:47], v[200:203], v[60:63]
    v_and_b32 v52, v31, v4
    v_and_b32 v53, v31, v5
    v_and_b32 v54, v31, v6
    v_and_b32 v55, v31, v7
    v_mfma_f32_16x16x32_bf16 v[16:19], v[48:51], v[152:155], v[16:19]
    v_mfma_f32_16x16x32_bf16 v[56:59], v[48:51], v[204:207], v[56:59]
    s_waitcnt lgkmcnt(1)
    v_and_b32 v40, v32, v4
    v_and_b32 v41, v32, v5
    v_and_b32 v42, v32, v6
    v_and_b32 v43, v32, v7
    v_mfma_f32_16x16x32_bf16 v[16:19], v[52:55], v[156:159], v[16:19]
    v_mfma_f32_16x16x32_bf16 v[60:63], v[52:55], v[204:207], v[60:63]
    v_and_b32 v44, v33, v4
    v_and_b32 v45, v33, v5
    v_and_b32 v46, v33, v6
    v_and_b32 v47, v33, v7
    v_mfma_f32_16x16x32_bf16 v[16:19], v[40:43], v[160:163], v[16:19]
    v_mfma_f32_16x16x32_bf16 v[56:59], v[40:43], v[208:211], v[56:59]
    v_and_b32 v48, v34, v4
    v_and_b32 v49, v34, v5
    v_and_b32 v50, v34, v6
    v_and_b32 v51, v34, v7
    v_mfma_f32_16x16x32_bf16 v[16:19], v[44:47], v[164:167], v[16:19]
    v_mfma_f32_16x16x32_bf16 v[60:63], v[44:47], v[208:211], v[60:63]
    v_and_b32 v52, v35, v4
    v_and_b32 v53, v35, v5
    v_and_b32 v54, v35, v6
    v_and_b32 v55, v35, v7
    v_mfma_f32_16x16x32_bf16 v[16:19], v[48:51], v[168:171], v[16:19]
    v_mfma_f32_16x16x32_bf16 v[56:59], v[48:51], v[212:215], v[56:59]
    s_waitcnt lgkmcnt(0)
    v_and_b32 v40, v36, v4
    v_and_b32 v41, v36, v5
    v_and_b32 v42, v36, v6
    v_and_b32 v43, v36, v7
    v_mfma_f32_16x16x32_bf16 v[16:19], v[52:55], v[172:175], v[16:19]
    v_mfma_f32_16x16x32_bf16 v[60:63], v[52:55], v[212:215], v[60:63]
    v_and_b32 v44, v37, v4
    v_and_b32 v45, v37, v5
    v_and_b32 v46, v37, v6
    v_and_b32 v47, v37, v7
    v_mfma_f32_16x16x32_bf16 v[16:19], v[40:43], v[176:179], v[16:19]
    v_mfma_f32_16x16x32_bf16 v[56:59], v[40:43], v[216:219], v[56:59]
    v_and_b32 v48, v38, v4
    v_and_b32 v49, v38, v5
    v_and_b32 v50, v38, v6
    v_and_b32 v51, v38, v7
    v_mfma_f32_16x16x32_bf16 v[16:19], v[44:47], v[180:183], v[16:19]
    v_mfma_f32_16x16x32_bf16 v[60:63], v[44:47], v[216:219], v[60:63]
    v_and_b32 v52, v39, v4
    v_and_b32 v53, v39, v5
    v_and_b32 v54, v39, v6
    v_and_b32 v55, v39, v7
    v_mfma_f32_16x16x32_bf16 v[16:19], v[48:51], v[184:187], v[16:19]
    v_mfma_f32_16x16x32_bf16 v[56:59], v[48:51], v[220:223], v[56:59]
    v_mfma_f32_16x16x32_bf16 v[16:19], v[52:55], v[188:191], v[16:19]
    v_mfma_f32_16x16x32_bf16 v[60:63], v[52:55], v[220:223], v[60:63]
    s_nop 6
    v_bfi_b32 v16, 15, s76, v16
    v_bfi_b32 v17, 15, s77, v17
    v_bfi_b32 v18, 15, s78, v18
    v_bfi_b32 v19, 15, s79, v19
    buffer_store_dwordx4 v[16:19], v118, s[36:39], s14 offen sc1
    v_add_f32_dpp v56, v60, v56 row_ror:8 row_mask:0xf bank_mask:0xf
    v_add_f32_dpp v57, v61, v57 row_ror:8 row_mask:0xf bank_mask:0xf
    v_add_f32_dpp v58, v62, v58 row_ror:8 row_mask:0xf bank_mask:0xf
    v_add_f32_dpp v59, v63, v59 row_ror:8 row_mask:0xf bank_mask:0xf
    v_bfi_b32 v56, 15, s76, v56
    v_bfi_b32 v57, 15, s77, v57
    v_bfi_b32 v58, 15, s78, v58
    v_bfi_b32 v59, 15, s79, v59
    s_mov_b64 exec, s[70:71]
    buffer_store_dwordx4 v[56:59], v118, s[36:39], s15 offen sc1
    s_mov_b64 exec, -1
    s_endpgm
L_side:
    s_setprio 3
    s_getpc_b64 s[80:81]
    v_lshlrev_b32 v1, 4, v0
    v_add_u32 v2, 4096, v1
    global_load_dwordx4 v[224:227], v1, s[80:81] offset:1024
    global_load_dwordx4 v[224:227], v1, s[80:81] offset:2048
    global_load_dwordx4 v[224:227], v1, s[80:81] offset:3072
    global_load_dwordx4 v[224:227], v2, s[80:81] offset:0
    global_load_dwordx4 v[224:227], v2, s[80:81] offset:1024
    s_mov_b32 s67, 4
    v_lshrrev_b32 v1, 5, v0
    v_mul_u32_u24 v1, 1152, v1
    v_and_b32 v2, 31, v0
    v_lshl_add_u32 v1, v2, 2, v1
    v_lshrrev_b32 v3, 4, v0
    v_bfe_u32 v2, v0, 3, 1
    v_lshl_add_u32 v3, v2, 2, v3
    v_mul_u32_u24 v3, 8192, v3
    v_and_b32 v2, 7, v0
    v_lshl_add_u32 v3, v2, 4, v3
    s_lshl_b32 s60, s54, 3
    s_add_u32 s60, s60, s53
    s_lshr_b32 s61, s60, 2
    s_add_u32 s60, s60, s55
    s_lshr_b32 s62, s55, 2
    s_add_u32 s60, s60, s62
    s_and_b32 s60, s60, 3
    s_mul_i32 s62, s61, 1179648
    s_lshl_b32 s58, s55, 9
    s_add_u32 s62, s62, s58
    s_lshl_b32 s58, s60, 7
    s_add_u32 s62, s62, s58
    s_mul_i32 s75, s52, 4352
    s_add_u32 s75, s75, 4096
    s_cmp_eq_u32 s53, 0
    s_cselect_b32 s59, s75, 4194304
    v_mov_b32 v35, 0
    s_waitcnt lgkmcnt(0)
    s_mov_b32 s36, s26
    s_mov_b32 s37, s27
    s_mov_b32 s38, 4194304
    s_mov_b32 s39, 0x20000
    buffer_store_dword v35, off, s[36:39], s59 sc1
    s_mov_b32 s44, s4
    s_mov_b32 s45, s5
    s_mov_b32 s46, 2304
    s_mov_b32 s47, 0x20000
    buffer_load_dword v24, v1, s[44:47], 0 offen offset:0
    buffer_load_dword v25, v1, s[44:47], 0 offen offset:128
    buffer_load_dword v26, v1, s[44:47], 0 offen offset:256
    buffer_load_dword v27, v1, s[44:47], 0 offen offset:384
    buffer_load_dword v28, v1, s[44:47], 0 offen offset:512
    buffer_load_dword v29, v1, s[44:47], 0 offen offset:640
    buffer_load_dword v30, v1, s[44:47], 0 offen offset:768
    buffer_load_dword v31, v1, s[44:47], 0 offen offset:896
    buffer_load_dword v32, v1, s[44:47], 0 offen offset:1024
    buffer_load_dword v33, off, s[36:39], 0 sc1
    s_add_u32 s40, s10, s62
    s_addc_u32 s41, s11, 0
    s_sub_u32 s42, 4718592, s62
    s_mov_b32 s43, 0x20000
    s_mov_b32 s58, 0
    buffer_load_dwordx4 v[64:67], v3, s[40:43], s58 offen nt
    s_add_u32 s58, s58, 65536
    buffer_load_dwordx4 v[68:71], v3, s[40:43], s58 offen nt
    s_add_u32 s58, s58, 65536
    buffer_load_dwordx4 v[72:75], v3, s[40:43], s58 offen nt
    s_add_u32 s58, s58, 65536
    buffer_load_dwordx4 v[76:79], v3, s[40:43], s58 offen nt
    s_add_u32 s58, s58, 65536
    buffer_load_dwordx4 v[80:83], v3, s[40:43], s58 offen nt
    s_add_u32 s58, s58, 65536
    buffer_load_dwordx4 v[84:87], v3, s[40:43], s58 offen nt
    s_add_u32 s58, s58, 65536
    buffer_load_dwordx4 v[88:91], v3, s[40:43], s58 offen nt
    s_add_u32 s58, s58, 65536
    buffer_load_dwordx4 v[92:95], v3, s[40:43], s58 offen nt
    s_add_u32 s58, s58, 65536
    buffer_load_dwordx4 v[96:99], v3, s[40:43], s58 offen nt
    s_add_u32 s58, s58, 65536
    buffer_load_dwordx4 v[100:103], v3, s[40:43], s58 offen nt
    s_add_u32 s58, s58, 65536
    buffer_load_dwordx4 v[104:107], v3, s[40:43], s58 offen nt
    s_add_u32 s58, s58, 65536
    buffer_load_dwordx4 v[108:111], v3, s[40:43], s58 offen nt
    s_add_u32 s58, s58, 65536
    buffer_load_dwordx4 v[112:115], v3, s[40:43], s58 offen nt
    s_add_u32 s58, s58, 65536
    buffer_load_dwordx4 v[116:119], v3, s[40:43], s58 offen nt
    s_add_u32 s58, s58, 65536
    buffer_load_dwordx4 v[120:123], v3, s[40:43], s58 offen nt
    s_add_u32 s58, s58, 65536
    buffer_load_dwordx4 v[124:127], v3, s[40:43], s58 offen nt
    s_add_u32 s58, s58, 65536
    buffer_load_dwordx4 v[128:131], v3, s[40:43], s58 offen nt
    s_add_u32 s58, s58, 65536
    buffer_load_dwordx4 v[132:135], v3, s[40:43], s58 offen nt
    s_cmp_lg_u32 s56, 1
    s_cbranch_scc1 L_nobar1
    s_barrier
L_nobar1:
    s_mov_b32 s63, 0x3db504f3
    s_mov_b32 s64, 0x3fb8aa3b
    s_mov_b32 s65, 0xbfb8aa3b
    s_mov_b32 s66, 0x40000
    s_mov_b32 s68, 0
    s_mov_b32 s69, -1
    s_mov_b32 s70, 0x00ff00ff
    s_mov_b32 s71, 0x00ff00ff
    v_and_b32 v1, 1, v0
    v_lshlrev_b32 v1, 4, v1
    v_mov_b32 v2, 0xffff
    v_lshlrev_b32 v1, v1, v2
    v_bfe_u32 v2, v0, 1, 2
    v_cmp_eq_u32 vcc, 0, v2
    s_nop 1
    v_cndmask_b32 v4, 0, v1, vcc
    v_cmp_eq_u32 vcc, 1, v2
    s_nop 1
    v_cndmask_b32 v5, 0, v1, vcc
    v_cmp_eq_u32 vcc, 2, v2
    s_nop 1
    v_cndmask_b32 v6, 0, v1, vcc
    v_cmp_eq_u32 vcc, 3, v2
    s_nop 1
    v_cndmask_b32 v7, 0, v1, vcc
    v_lshlrev_b32 v1, 2, v0
    ds_write_b32 v1, v35 offset:10320
    ds_write_b32 v1, v35 offset:10368
    ds_write_b32 v1, v35 offset:10624
    ds_write_b32 v1, v35 offset:10880
    ds_write_b32 v1, v35 offset:11136
    s_lshl_b32 s59, s53, 9
    s_add_u32 s59, s59, 1
    v_lshl_add_u32 v36, v0, 17, s59
    v_lshl_add_u32 v36, v0, 24, v36
    v_or_b32 v37, 2, v36
    s_cmp_eq_u32 s56, 1
    s_mov_b32 s72, 0x3fffff
    s_cselect_b32 s72, 0x3fffff, s72
    s_cselect_b32 s73, 0, 0
    v_add_u32 v2, s73, v1
    s_mov_b32 exec_hi, s72
    ds_write_b32 v1, v36 offset:10368
    ds_write_b32 v2, v37 offset:10584
    s_mov_b64 exec, -1
    v_and_b32 v1, 1, v0
    v_lshlrev_b32 v1, 2, v1
    v_lshrrev_b32 v2, 5, v0
    v_add_u32 v1, v1, v2
    v_mul_u32_u24 v1, 576, v1
    v_bfe_u32 v2, v0, 1, 4
    v_lshl_add_u32 v1, v2, 2, v1
    v_lshrrev_b32 v3, 3, v0
    v_mul_u32_u24 v3, 576, v3
    s_mul_i32 s62, s61, 144
    v_add_u32 v3, s62, v3
    v_lshrrev_b32 v34, 5, v0
    v_lshlrev_b32 v34, 12, v34
    v_and_b32 v2, 7, v0
    v_lshl_add_u32 v34, v2, 5, v34
    v_and_b32 v2, 16, v0
    v_add_u32 v34, v34, v2
    s_lshl_b32 s62, s55, 13
    s_lshl_b32 s61, s61, 10
    s_add_u32 s62, s62, s61
    s_lshl_b32 s60, s60, 8
    s_add_u32 s62, s62, s60
    s_add_u32 s62, s62, 262144
    s_waitcnt vmcnt(18)
    v_readfirstlane_b32 s60, v33
    ds_write_b32 v35, v33 offset:10304
    v_lshlrev_b32 v136, 16, v24
    v_and_b32 v137, 0xffff0000, v24
    v_lshlrev_b32 v138, 16, v25
    v_and_b32 v139, 0xffff0000, v25
    v_lshlrev_b32 v140, 16, v26
    v_and_b32 v141, 0xffff0000, v26
    v_lshlrev_b32 v142, 16, v27
    v_and_b32 v143, 0xffff0000, v27
    v_lshlrev_b32 v144, 16, v28
    v_and_b32 v145, 0xffff0000, v28
    v_lshlrev_b32 v146, 16, v29
    v_and_b32 v147, 0xffff0000, v29
    v_lshlrev_b32 v148, 16, v30
    v_and_b32 v149, 0xffff0000, v30
    v_lshlrev_b32 v150, 16, v31
    v_and_b32 v151, 0xffff0000, v31
    v_lshlrev_b32 v152, 16, v32
    v_and_b32 v153, 0xffff0000, v32
    s_add_u32 s76, s60, 1
    s_add_u32 s77, s60, 6
    s_add_u32 s78, s60, 11
    s_add_u32 s79, s60, 14
    v_add_f32 v8, v136, v137
    v_add_f32 v9, v138, v139
    v_add_f32 v8, v8, v140
    v_add_f32 v9, v9, v141
    v_add_f32 v8, v8, v142
    v_add_f32 v9, v9, v143
    v_add_f32 v8, v8, v144
    v_add_f32 v9, v9, v145
    v_add_f32 v8, v8, v146
    v_add_f32 v9, v9, v147
    v_add_f32 v8, v8, v148
    v_add_f32 v9, v9, v149
    v_add_f32 v8, v8, v150
    v_add_f32 v9, v9, v151
    v_add_f32 v8, v8, v152
    v_add_f32 v9, v9, v153
    v_add_f32 v8, v8, v9
    s_nop 1
    v_add_f32_dpp v8, v8, v8 quad_perm:[1,0,3,2] row_mask:0xf bank_mask:0xf
    s_nop 1
    v_add_f32_dpp v8, v8, v8 quad_perm:[2,3,0,1] row_mask:0xf bank_mask:0xf
    s_nop 1
    v_add_f32_dpp v8, v8, v8 row_half_mirror row_mask:0xf bank_mask:0xf
    s_nop 1
    v_add_f32_dpp v8, v8, v8 row_mirror row_mask:0xf bank_mask:0xf
    v_mov_b32 v9, v8
    s_nop 1
    v_permlane16_swap_b32 v8, v9
    v_add_f32 v8, v8, v9
    v_mul_f32 v8, 0x3ae38e39, v8
    v_sub_f32 v12, v136, v8
    v_sub_f32 v13, v137, v8
    v_mul_f32 v10, v12, v12
    v_mul_f32 v11, v13, v13
    v_sub_f32 v12, v138, v8
    v_sub_f32 v13, v139, v8
    v_fmac_f32 v10, v12, v12
    v_fmac_f32 v11, v13, v13
    v_sub_f32 v12, v140, v8
    v_sub_f32 v13, v141, v8
    v_fmac_f32 v10, v12, v12
    v_fmac_f32 v11, v13, v13
    v_sub_f32 v12, v142, v8
    v_sub_f32 v13, v143, v8
    v_fmac_f32 v10, v12, v12
    v_fmac_f32 v11, v13, v13
    v_sub_f32 v12, v144, v8
    v_sub_f32 v13, v145, v8
    v_fmac_f32 v10, v12, v12
    v_fmac_f32 v11, v13, v13
    v_sub_f32 v12, v146, v8
    v_sub_f32 v13, v147, v8
    v_fmac_f32 v10, v12, v12
    v_fmac_f32 v11, v13, v13
    v_sub_f32 v12, v148, v8
    v_sub_f32 v13, v149, v8
    v_fmac_f32 v10, v12, v12
    v_fmac_f32 v11, v13, v13
    v_sub_f32 v12, v150, v8
    v_sub_f32 v13, v151, v8
    v_fmac_f32 v10, v12, v12
    v_fmac_f32 v11, v13, v13
    v_sub_f32 v12, v152, v8
    v_sub_f32 v13, v153, v8
    v_fmac_f32 v10, v12, v12
    v_fmac_f32 v11, v13, v13
    v_add_f32 v10, v10, v11
    s_nop 1
    v_add_f32_dpp v10, v10, v10 quad_perm:[1,0,3,2] row_mask:0xf bank_mask:0xf
    s_nop 1
    v_add_f32_dpp v10, v10, v10 quad_perm:[2,3,0,1] row_mask:0xf bank_mask:0xf
    s_nop 1
    v_add_f32_dpp v10, v10, v10 row_half_mirror row_mask:0xf bank_mask:0xf
    s_nop 1
    v_add_f32_dpp v10, v10, v10 row_mirror row_mask:0xf bank_mask:0xf
    v_mov_b32 v9, v10
    s_nop 1
    v_permlane16_swap_b32 v10, v9
    v_add_f32 v10, v10, v9
    v_mul_f32 v10, 0x3ae38e39, v10
    v_cvt_pk_bf16_f32 v8, v8, v8
    v_and_b32 v8, 0xffff0000, v8
    v_cvt_pk_bf16_f32 v10, v10, v10
    v_and_b32 v10, 0xffff0000, v10
    v_add_f32 v10, 0x3727c5ac, v10
    v_cvt_pk_bf16_f32 v10, v10, v10
    v_and_b32 v10, 0xffff0000, v10
    v_sqrt_f32 v10, v10
    s_nop 0
    v_cvt_pk_bf16_f32 v10, v10, v10
    v_and_b32 v10, 0xffff0000, v10
    v_rcp_f32 v10, v10
    v_sub_f32 v136, v136, v8
    v_sub_f32 v137, v137, v8
    v_cvt_pk_bf16_f32 v137, v136, v137
    v_lshlrev_b32 v136, 16, v137
    v_and_b32 v137, 0xffff0000, v137
    v_mul_f32 v136, v136, v10
    v_mul_f32 v137, v137, v10
    v_cvt_pk_bf16_f32 v136, v136, v136
    v_cvt_pk_bf16_f32 v137, v137, v137
    ds_write_b32 v1, v136 offset:0
    ds_write_b32 v1, v137 offset:1152
    v_sub_f32 v138, v138, v8
    v_sub_f32 v139, v139, v8
    v_cvt_pk_bf16_f32 v139, v138, v139
    v_lshlrev_b32 v138, 16, v139
    v_and_b32 v139, 0xffff0000, v139
    v_mul_f32 v138, v138, v10
    v_mul_f32 v139, v139, v10
    v_cvt_pk_bf16_f32 v138, v138, v138
    v_cvt_pk_bf16_f32 v139, v139, v139
    ds_write_b32 v1, v138 offset:64
    ds_write_b32 v1, v139 offset:1216
    v_sub_f32 v140, v140, v8
    v_sub_f32 v141, v141, v8
    v_cvt_pk_bf16_f32 v141, v140, v141
    v_lshlrev_b32 v140, 16, v141
    v_and_b32 v141, 0xffff0000, v141
    v_mul_f32 v140, v140, v10
    v_mul_f32 v141, v141, v10
    v_cvt_pk_bf16_f32 v140, v140, v140
    v_cvt_pk_bf16_f32 v141, v141, v141
    ds_write_b32 v1, v140 offset:128
    ds_write_b32 v1, v141 offset:1280
    v_sub_f32 v142, v142, v8
    v_sub_f32 v143, v143, v8
    v_cvt_pk_bf16_f32 v143, v142, v143
    v_lshlrev_b32 v142, 16, v143
    v_and_b32 v143, 0xffff0000, v143
    v_mul_f32 v142, v142, v10
    v_mul_f32 v143, v143, v10
    v_cvt_pk_bf16_f32 v142, v142, v142
    v_cvt_pk_bf16_f32 v143, v143, v143
    ds_write_b32 v1, v142 offset:192
    ds_write_b32 v1, v143 offset:1344
    v_sub_f32 v144, v144, v8
    v_sub_f32 v145, v145, v8
    v_cvt_pk_bf16_f32 v145, v144, v145
    v_lshlrev_b32 v144, 16, v145
    v_and_b32 v145, 0xffff0000, v145
    v_mul_f32 v144, v144, v10
    v_mul_f32 v145, v145, v10
    v_cvt_pk_bf16_f32 v144, v144, v144
    v_cvt_pk_bf16_f32 v145, v145, v145
    ds_write_b32 v1, v144 offset:256
    ds_write_b32 v1, v145 offset:1408
    v_sub_f32 v146, v146, v8
    v_sub_f32 v147, v147, v8
    v_cvt_pk_bf16_f32 v147, v146, v147
    v_lshlrev_b32 v146, 16, v147
    v_and_b32 v147, 0xffff0000, v147
    v_mul_f32 v146, v146, v10
    v_mul_f32 v147, v147, v10
    v_cvt_pk_bf16_f32 v146, v146, v146
    v_cvt_pk_bf16_f32 v147, v147, v147
    ds_write_b32 v1, v146 offset:320
    ds_write_b32 v1, v147 offset:1472
    v_sub_f32 v148, v148, v8
    v_sub_f32 v149, v149, v8
    v_cvt_pk_bf16_f32 v149, v148, v149
    v_lshlrev_b32 v148, 16, v149
    v_and_b32 v149, 0xffff0000, v149
    v_mul_f32 v148, v148, v10
    v_mul_f32 v149, v149, v10
    v_cvt_pk_bf16_f32 v148, v148, v148
    v_cvt_pk_bf16_f32 v149, v149, v149
    ds_write_b32 v1, v148 offset:384
    ds_write_b32 v1, v149 offset:1536
    v_sub_f32 v150, v150, v8
    v_sub_f32 v151, v151, v8
    v_cvt_pk_bf16_f32 v151, v150, v151
    v_lshlrev_b32 v150, 16, v151
    v_and_b32 v151, 0xffff0000, v151
    v_mul_f32 v150, v150, v10
    v_mul_f32 v151, v151, v10
    v_cvt_pk_bf16_f32 v150, v150, v150
    v_cvt_pk_bf16_f32 v151, v151, v151
    ds_write_b32 v1, v150 offset:448
    ds_write_b32 v1, v151 offset:1600
    v_sub_f32 v152, v152, v8
    v_sub_f32 v153, v153, v8
    v_cvt_pk_bf16_f32 v153, v152, v153
    v_lshlrev_b32 v152, 16, v153
    v_and_b32 v153, 0xffff0000, v153
    v_mul_f32 v152, v152, v10
    v_mul_f32 v153, v153, v10
    v_cvt_pk_bf16_f32 v152, v152, v152
    v_cvt_pk_bf16_f32 v153, v153, v153
    ds_write_b32 v1, v152 offset:512
    ds_write_b32 v1, v153 offset:1664
    s_waitcnt lgkmcnt(0)
    ds_read_b128 v[136:139], v3 offset:0
    ds_read_b128 v[140:143], v3 offset:16
    ds_read_b128 v[144:147], v3 offset:32
    ds_read_b128 v[148:151], v3 offset:48
    ds_read_b128 v[152:155], v3 offset:64
    ds_read_b128 v[156:159], v3 offset:80
    ds_read_b128 v[160:163], v3 offset:96
    ds_read_b128 v[164:167], v3 offset:112
    ds_read_b128 v[168:171], v3 offset:128
    v_mov_b32 v8, 0
    v_mov_b32 v9, 0
    v_mov_b32 v10, 0
    v_mov_b32 v11, 0
    v_mov_b32 v12, 0
    v_mov_b32 v13, 0
    v_mov_b32 v14, 0
    v_mov_b32 v15, 0
    s_waitcnt lgkmcnt(8)
    v_and_b32 v40, v136, v4
    v_and_b32 v41, v136, v5
    v_and_b32 v42, v136, v6
    v_and_b32 v43, v136, v7
    v_and_b32 v44, v137, v4
    v_and_b32 v45, v137, v5
    v_and_b32 v46, v137, v6
    v_and_b32 v47, v137, v7
    v_and_b32 v48, v138, v4
    v_and_b32 v49, v138, v5
    v_and_b32 v50, v138, v6
    v_and_b32 v51, v138, v7
    v_and_b32 v52, v139, v4
    v_and_b32 v53, v139, v5
    v_and_b32 v54, v139, v6
    v_and_b32 v55, v139, v7
    s_waitcnt vmcnt(12)
    v_mfma_f32_16x16x32_bf16 v[8:11], v[40:43], v[64:67], v[8:11]
    v_mfma_f32_16x16x32_bf16 v[12:15], v[44:47], v[64:67], v[12:15]
    s_waitcnt lgkmcnt(7)
    v_and_b32 v40, v140, v4
    v_and_b32 v41, v140, v5
    v_and_b32 v42, v140, v6
    v_and_b32 v43, v140, v7
    v_and_b32 v44, v141, v4
    v_and_b32 v45, v141, v5
    v_and_b32 v46, v141, v6
    v_and_b32 v47, v141, v7
    v_mfma_f32_16x16x32_bf16 v[8:11], v[48:51], v[68:71], v[8:11]
    v_mfma_f32_16x16x32_bf16 v[12:15], v[52:55], v[68:71], v[12:15]
    v_and_b32 v48, v142, v4
    v_and_b32 v49, v142, v5
    v_and_b32 v50, v142, v6
    v_and_b32 v51, v142, v7
    v_and_b32 v52, v143, v4
    v_and_b32 v53, v143, v5
    v_and_b32 v54, v143, v6
    v_and_b32 v55, v143, v7
    v_mfma_f32_16x16x32_bf16 v[8:11], v[40:43], v[72:75], v[8:11]
    v_mfma_f32_16x16x32_bf16 v[12:15], v[44:47], v[72:75], v[12:15]
    s_waitcnt lgkmcnt(6)
    v_and_b32 v40, v144, v4
    v_and_b32 v41, v144, v5
    v_and_b32 v42, v144, v6
    v_and_b32 v43, v144, v7
    v_and_b32 v44, v145, v4
    v_and_b32 v45, v145, v5
    v_and_b32 v46, v145, v6
    v_and_b32 v47, v145, v7
    v_mfma_f32_16x16x32_bf16 v[8:11], v[48:51], v[76:79], v[8:11]
    v_mfma_f32_16x16x32_bf16 v[12:15], v[52:55], v[76:79], v[12:15]
    v_and_b32 v48, v146, v4
    v_and_b32 v49, v146, v5
    v_and_b32 v50, v146, v6
    v_and_b32 v51, v146, v7
    v_and_b32 v52, v147, v4
    v_and_b32 v53, v147, v5
    v_and_b32 v54, v147, v6
    v_and_b32 v55, v147, v7
    v_mfma_f32_16x16x32_bf16 v[8:11], v[40:43], v[80:83], v[8:11]
    v_mfma_f32_16x16x32_bf16 v[12:15], v[44:47], v[80:83], v[12:15]
    s_waitcnt lgkmcnt(5)
    v_and_b32 v40, v148, v4
    v_and_b32 v41, v148, v5
    v_and_b32 v42, v148, v6
    v_and_b32 v43, v148, v7
    v_and_b32 v44, v149, v4
    v_and_b32 v45, v149, v5
    v_and_b32 v46, v149, v6
    v_and_b32 v47, v149, v7
    v_mfma_f32_16x16x32_bf16 v[8:11], v[48:51], v[84:87], v[8:11]
    v_mfma_f32_16x16x32_bf16 v[12:15], v[52:55], v[84:87], v[12:15]
    v_and_b32 v48, v150, v4
    v_and_b32 v49, v150, v5
    v_and_b32 v50, v150, v6
    v_and_b32 v51, v150, v7
    v_and_b32 v52, v151, v4
    v_and_b32 v53, v151, v5
    v_and_b32 v54, v151, v6
    v_and_b32 v55, v151, v7
    s_waitcnt vmcnt(6)
    v_mfma_f32_16x16x32_bf16 v[8:11], v[40:43], v[88:91], v[8:11]
    v_mfma_f32_16x16x32_bf16 v[12:15], v[44:47], v[88:91], v[12:15]
    s_waitcnt lgkmcnt(4)
    v_and_b32 v40, v152, v4
    v_and_b32 v41, v152, v5
    v_and_b32 v42, v152, v6
    v_and_b32 v43, v152, v7
    v_and_b32 v44, v153, v4
    v_and_b32 v45, v153, v5
    v_and_b32 v46, v153, v6
    v_and_b32 v47, v153, v7
    v_mfma_f32_16x16x32_bf16 v[8:11], v[48:51], v[92:95], v[8:11]
    v_mfma_f32_16x16x32_bf16 v[12:15], v[52:55], v[92:95], v[12:15]
    v_and_b32 v48, v154, v4
    v_and_b32 v49, v154, v5
    v_and_b32 v50, v154, v6
    v_and_b32 v51, v154, v7
    v_and_b32 v52, v155, v4
    v_and_b32 v53, v155, v5
    v_and_b32 v54, v155, v6
    v_and_b32 v55, v155, v7
    v_mfma_f32_16x16x32_bf16 v[8:11], v[40:43], v[96:99], v[8:11]
    v_mfma_f32_16x16x32_bf16 v[12:15], v[44:47], v[96:99], v[12:15]
    s_waitcnt lgkmcnt(3)
    v_and_b32 v40, v156, v4
    v_and_b32 v41, v156, v5
    v_and_b32 v42, v156, v6
    v_and_b32 v43, v156, v7
    v_and_b32 v44, v157, v4
    v_and_b32 v45, v157, v5
    v_and_b32 v46, v157, v6
    v_and_b32 v47, v157, v7
    v_mfma_f32_16x16x32_bf16 v[8:11], v[48:51], v[100:103], v[8:11]
    v_mfma_f32_16x16x32_bf16 v[12:15], v[52:55], v[100:103], v[12:15]
    v_and_b32 v48, v158, v4
    v_and_b32 v49, v158, v5
    v_and_b32 v50, v158, v6
    v_and_b32 v51, v158, v7
    v_and_b32 v52, v159, v4
    v_and_b32 v53, v159, v5
    v_and_b32 v54, v159, v6
    v_and_b32 v55, v159, v7
    v_mfma_f32_16x16x32_bf16 v[8:11], v[40:43], v[104:107], v[8:11]
    v_mfma_f32_16x16x32_bf16 v[12:15], v[44:47], v[104:107], v[12:15]
    s_waitcnt lgkmcnt(2)
    v_and_b32 v40, v160, v4
    v_and_b32 v41, v160, v5
    v_and_b32 v42, v160, v6
    v_and_b32 v43, v160, v7
    v_and_b32 v44, v161, v4
    v_and_b32 v45, v161, v5
    v_and_b32 v46, v161, v6
    v_and_b32 v47, v161, v7
    v_mfma_f32_16x16x32_bf16 v[8:11], v[48:51], v[108:111], v[8:11]
    v_mfma_f32_16x16x32_bf16 v[12:15], v[52:55], v[108:111], v[12:15]
    v_and_b32 v48, v162, v4
    v_and_b32 v49, v162, v5
    v_and_b32 v50, v162, v6
    v_and_b32 v51, v162, v7
    v_and_b32 v52, v163, v4
    v_and_b32 v53, v163, v5
    v_and_b32 v54, v163, v6
    v_and_b32 v55, v163, v7
    s_waitcnt vmcnt(0)
    v_mfma_f32_16x16x32_bf16 v[8:11], v[40:43], v[112:115], v[8:11]
    v_mfma_f32_16x16x32_bf16 v[12:15], v[44:47], v[112:115], v[12:15]
    s_waitcnt lgkmcnt(1)
    v_and_b32 v40, v164, v4
    v_and_b32 v41, v164, v5
    v_and_b32 v42, v164, v6
    v_and_b32 v43, v164, v7
    v_and_b32 v44, v165, v4
    v_and_b32 v45, v165, v5
    v_and_b32 v46, v165, v6
    v_and_b32 v47, v165, v7
    v_mfma_f32_16x16x32_bf16 v[8:11], v[48:51], v[116:119], v[8:11]
    v_mfma_f32_16x16x32_bf16 v[12:15], v[52:55], v[116:119], v[12:15]
    v_and_b32 v48, v166, v4
    v_and_b32 v49, v166, v5
    v_and_b32 v50, v166, v6
    v_and_b32 v51, v166, v7
    v_and_b32 v52, v167, v4
    v_and_b32 v53, v167, v5
    v_and_b32 v54, v167, v6
    v_and_b32 v55, v167, v7
    v_mfma_f32_16x16x32_bf16 v[8:11], v[40:43], v[120:123], v[8:11]
    v_mfma_f32_16x16x32_bf16 v[12:15], v[44:47], v[120:123], v[12:15]
    s_waitcnt lgkmcnt(0)
    v_and_b32 v40, v168, v4
    v_and_b32 v41, v168, v5
    v_and_b32 v42, v168, v6
    v_and_b32 v43, v168, v7
    v_and_b32 v44, v169, v4
    v_and_b32 v45, v169, v5
    v_and_b32 v46, v169, v6
    v_and_b32 v47, v169, v7
    v_mfma_f32_16x16x32_bf16 v[8:11], v[48:51], v[124:127], v[8:11]
    v_mfma_f32_16x16x32_bf16 v[12:15], v[52:55], v[124:127], v[12:15]
    v_and_b32 v48, v170, v4
    v_and_b32 v49, v170, v5
    v_and_b32 v50, v170, v6
    v_and_b32 v51, v170, v7
    v_and_b32 v52, v171, v4
    v_and_b32 v53, v171, v5
    v_and_b32 v54, v171, v6
    v_and_b32 v55, v171, v7
    v_mfma_f32_16x16x32_bf16 v[8:11], v[40:43], v[128:131], v[8:11]
    v_mfma_f32_16x16x32_bf16 v[12:15], v[44:47], v[128:131], v[12:15]
    v_mfma_f32_16x16x32_bf16 v[8:11], v[48:51], v[132:135], v[8:11]
    v_mfma_f32_16x16x32_bf16 v[12:15], v[52:55], v[132:135], v[12:15]
    s_nop 7
    v_add_f32_dpp v8, v12, v8 row_ror:8 row_mask:0xf bank_mask:0xf
    v_add_f32_dpp v9, v13, v9 row_ror:8 row_mask:0xf bank_mask:0xf
    v_add_f32_dpp v10, v14, v10 row_ror:8 row_mask:0xf bank_mask:0xf
    v_add_f32_dpp v11, v15, v11 row_ror:8 row_mask:0xf bank_mask:0xf
    v_bfi_b32 v8, 15, s76, v8
    v_bfi_b32 v9, 15, s77, v9
    v_bfi_b32 v10, 15, s78, v10
    v_bfi_b32 v11, 15, s79, v11
    s_mov_b64 exec, s[70:71]
    buffer_store_dwordx4 v[8:11], v34, s[36:39], s62 offen sc1
    s_mov_b64 exec, -1
    v_mov_b32 v192, v37
    s_mov_b32 s48, s22
    s_mov_b32 s49, s23
    s_mov_b32 s50, 2304
    s_mov_b32 s51, 0x20000
    s_cmp_lg_u32 s56, 1
    s_cbranch_scc1 L_nogu
    s_lshl_b32 s62, s57, 7
    s_add_u32 s40, s16, s62
    s_addc_u32 s41, s17, 0
    s_sub_u32 s42, 5308416, s62
    s_mov_b32 s43, 0x20000
    s_add_u32 s44, s18, s62
    s_addc_u32 s45, s19, 0
    s_sub_u32 s46, 5308416, s62
    s_mov_b32 s47, 0x20000
    v_lshrrev_b32 v3, 4, v0
    v_bfe_u32 v2, v0, 3, 1
    v_lshl_add_u32 v3, v2, 2, v3
    v_mul_u32_u24 v3, 9216, v3
    v_and_b32 v2, 7, v0
    v_lshl_add_u32 v3, v2, 4, v3
    s_mov_b32 s58, 4718592
    buffer_load_dwordx4 v[128:131], v3, s[40:43], s58 offen nt
    buffer_load_dwordx4 v[132:135], v3, s[44:47], s58 offen nt
    s_add_u32 s58, s58, 73728
    buffer_load_dwordx4 v[136:139], v3, s[40:43], s58 offen nt
    buffer_load_dwordx4 v[140:143], v3, s[44:47], s58 offen nt
    s_add_u32 s58, s58, 73728
    buffer_load_dwordx4 v[144:147], v3, s[40:43], s58 offen nt
    buffer_load_dwordx4 v[148:151], v3, s[44:47], s58 offen nt
    s_add_u32 s58, s58, 73728
    buffer_load_dwordx4 v[152:155], v3, s[40:43], s58 offen nt
    buffer_load_dwordx4 v[156:159], v3, s[44:47], s58 offen nt
    s_add_u32 s58, s58, 73728
    buffer_load_dwordx4 v[160:163], v3, s[40:43], s58 offen nt
    buffer_load_dwordx4 v[164:167], v3, s[44:47], s58 offen nt
    s_add_u32 s58, s58, 73728
    buffer_load_dwordx4 v[168:171], v3, s[40:43], s58 offen nt
    buffer_load_dwordx4 v[172:175], v3, s[44:47], s58 offen nt
    s_add_u32 s58, s58, 73728
    buffer_load_dwordx4 v[176:179], v3, s[40:43], s58 offen nt
    buffer_load_dwordx4 v[180:183], v3, s[44:47], s58 offen nt
    s_add_u32 s58, s58, 73728
    buffer_load_dwordx4 v[184:187], v3, s[40:43], s58 offen nt
    buffer_load_dwordx4 v[188:191], v3, s[44:47], s58 offen nt
L_nogu:
    s_lshl_b32 s62, s55, 1
    s_add_u32 s62, s62, s54
    s_lshl_b32 s62, s62, 12
    s_add_u32 s62, s62, 262144
    v_lshlrev_b32 v1, 4, v0
    v_lshlrev_b32 v3, 3, v0
    s_waitcnt vmcnt(0)
    s_sleep 10
L_q_poll:
    s_sleep 4
    buffer_load_dwordx4 v[64:67], v1, s[36:39], s62 offen offset:0 sc1
    buffer_load_dwordx4 v[68:71], v1, s[36:39], s62 offen offset:1024 sc1
    buffer_load_dwordx4 v[72:75], v1, s[36:39], s62 offen offset:2048 sc1
    buffer_load_dwordx4 v[76:79], v1, s[36:39], s62 offen offset:3072 sc1
    s_waitcnt vmcnt(0)
    v_xor_b32 v8, s76, v64
    v_xor_b32 v9, s77, v65
    v_bitop3_b32 v8, v66, s78, v8 bitop3:0xbe
    v_bitop3_b32 v9, v67, s79, v9 bitop3:0xbe
    v_bitop3_b32 v8, v68, s76, v8 bitop3:0xbe
    v_bitop3_b32 v9, v69, s77, v9 bitop3:0xbe
    v_bitop3_b32 v8, v70, s78, v8 bitop3:0xbe
    v_bitop3_b32 v9, v71, s79, v9 bitop3:0xbe
    v_bitop3_b32 v8, v72, s76, v8 bitop3:0xbe
    v_bitop3_b32 v9, v73, s77, v9 bitop3:0xbe
    v_bitop3_b32 v8, v74, s78, v8 bitop3:0xbe
    v_bitop3_b32 v9, v75, s79, v9 bitop3:0xbe
    v_bitop3_b32 v8, v76, s76, v8 bitop3:0xbe
    v_bitop3_b32 v9, v77, s77, v9 bitop3:0xbe
    v_bitop3_b32 v8, v78, s78, v8 bitop3:0xbe
    v_bitop3_b32 v9, v79, s79, v9 bitop3:0xbe
    v_bitop3_b32 v8, v8, v9, 15 bitop3:0xa8
    v_cmp_ne_u32 vcc, 0, v8
    s_cbranch_vccz L_q_ok
    s_sub_u32 s66, s66, 1
    s_cmp_gt_i32 s66, 0
    s_cbranch_scc1 L_q_poll
L_q_ok:
    v_and_b32 v64, -16, v64
    v_and_b32 v65, -16, v65
    v_and_b32 v66, -16, v66
    v_and_b32 v67, -16, v67
    v_and_b32 v68, -16, v68
    v_and_b32 v69, -16, v69
    v_and_b32 v70, -16, v70
    v_and_b32 v71, -16, v71
    v_and_b32 v72, -16, v72
    v_and_b32 v73, -16, v73
    v_and_b32 v74, -16, v74
    v_and_b32 v75, -16, v75
    v_and_b32 v76, -16, v76
    v_and_b32 v77, -16, v77
    v_and_b32 v78, -16, v78
    v_and_b32 v79, -16, v79
    v_add_f32 v64, v64, v68
    v_add_f32 v72, v72, v76
    v_add_f32 v65, v65, v69
    v_add_f32 v73, v73, v77
    v_add_f32 v66, v66, v70
    v_add_f32 v74, v74, v78
    v_add_f32 v67, v67, v71
    v_add_f32 v75, v75, v79
    v_add_f32 v64, v64, v72
    v_add_f32 v65, v65, v73
    v_add_f32 v66, v66, v74
    v_add_f32 v67, v67, v75
    v_cvt_pk_bf16_f32 v8, v64, v65
    v_cvt_pk_bf16_f32 v9, v66, v67
    ds_write_b64 v3, v[8:9] offset:4608
    s_waitcnt lgkmcnt(0)
    s_barrier
    s_setprio 0
    s_cmp_eq_u32 s56, 1
    s_cbranch_scc1 L_ffn
    v_bfe_u32 v1, v0, 3, 1
    v_lshlrev_b32 v1, 8, v1
    v_and_b32 v2, 3, v0
    v_lshl_add_u32 v1, v2, 6, v1
    v_lshrrev_b32 v2, 4, v0
    v_lshl_add_u32 v1, v2, 4, v1
    ds_read_b128 v[12:15], v1 offset:4608
    v_lshlrev_b32 v1, 4, v0
    v_add_u32 v1, 27776, v1
    v_and_b32 v113, 0x38, v0
    s_mov_b32 s59, 0
L_cu_loop:
    ds_read_b128 v[64:67], v1 offset:0
    ds_read_b128 v[68:71], v1 offset:1024
    ds_read_b128 v[72:75], v1 offset:2048
    ds_read_b128 v[76:79], v1 offset:3072
    v_add_u32 v1, 4096, v1
    s_and_b32 s61, s59, 3
    s_lshl_b32 s61, s61, 12
    s_lshr_b32 s62, s59, 2
    s_add_u32 s62, s62, 54
    s_lshl_b32 s62, s62, 6
    s_add_u32 s61, s61, s62
    v_add_u32 v114, s61, v113
    s_waitcnt lgkmcnt(0)
    v_mfma_f32_16x16x32_bf16 v[24:27], v[64:67], v[12:15], 0
    v_mfma_f32_16x16x32_bf16 v[28:31], v[68:71], v[12:15], 0
    v_mfma_f32_16x16x32_bf16 v[32:35], v[72:75], v[12:15], 0
    v_mfma_f32_16x16x32_bf16 v[36:39], v[76:79], v[12:15], 0
    s_nop 4
    v_mov_b32_dpp v40, v24 quad_perm:[0,0,0,0] row_mask:0xf bank_mask:0xf
    v_mov_b32_dpp v41, v28 quad_perm:[0,0,0,0] row_mask:0xf bank_mask:0xf
    v_mov_b32_dpp v42, v32 quad_perm:[0,0,0,0] row_mask:0xf bank_mask:0xf
    v_mov_b32_dpp v43, v36 quad_perm:[0,0,0,0] row_mask:0xf bank_mask:0xf
    v_add_f32_dpp v40, v25, v40 quad_perm:[1,1,1,1] row_mask:0xf bank_mask:0xf
    v_add_f32_dpp v41, v29, v41 quad_perm:[1,1,1,1] row_mask:0xf bank_mask:0xf
    v_add_f32_dpp v42, v33, v42 quad_perm:[1,1,1,1] row_mask:0xf bank_mask:0xf
    v_add_f32_dpp v43, v37, v43 quad_perm:[1,1,1,1] row_mask:0xf bank_mask:0xf
    v_add_f32_dpp v40, v26, v40 quad_perm:[2,2,2,2] row_mask:0xf bank_mask:0xf
    v_add_f32_dpp v41, v30, v41 quad_perm:[2,2,2,2] row_mask:0xf bank_mask:0xf
    v_add_f32_dpp v42, v34, v42 quad_perm:[2,2,2,2] row_mask:0xf bank_mask:0xf
    v_add_f32_dpp v43, v38, v43 quad_perm:[2,2,2,2] row_mask:0xf bank_mask:0xf
    v_add_f32_dpp v40, v27, v40 quad_perm:[3,3,3,3] row_mask:0xf bank_mask:0xf
    v_add_f32_dpp v41, v31, v41 quad_perm:[3,3,3,3] row_mask:0xf bank_mask:0xf
    v_add_f32_dpp v42, v35, v42 quad_perm:[3,3,3,3] row_mask:0xf bank_mask:0xf
    v_add_f32_dpp v43, v39, v43 quad_perm:[3,3,3,3] row_mask:0xf bank_mask:0xf
    v_cvt_pk_bf16_f32 v44, v40, v41
    v_cvt_pk_bf16_f32 v45, v42, v43
    v_lshlrev_b32 v40, 16, v44
    v_and_b32 v41, 0xffff0000, v44
    v_lshlrev_b32 v42, 16, v45
    v_and_b32 v43, 0xffff0000, v45
    v_mul_f32 v40, s63, v40
    v_mul_f32 v41, s63, v41
    v_mul_f32 v42, s63, v42
    v_mul_f32 v43, s63, v43
    v_cvt_pk_bf16_f32 v44, v40, v41
    v_cvt_pk_bf16_f32 v45, v42, v43
    ds_write_b64 v114, v[44:45] offset:11392
    s_add_u32 s59, s59, 1
    s_cmp_lg_u32 s59, 32
    s_cbranch_scc1 L_cu_loop
    v_lshlrev_b32 v1, 2, v0
    s_waitcnt lgkmcnt(0)
    s_mov_b32 exec_lo, 0
    s_mov_b32 exec_hi, 0x3fc00000
    ds_write_b32 v1, v192 offset:10584
    s_mov_b64 exec, -1
    s_branch L_agent
L_ffn:
    v_mov_b32 v24, 0
    v_mov_b32 v25, 0
    v_mov_b32 v26, 0
    v_mov_b32 v27, 0
    v_mov_b32 v28, 0
    v_mov_b32 v29, 0
    v_mov_b32 v30, 0
    v_mov_b32 v31, 0
    v_mov_b32 v32, 0
    v_mov_b32 v33, 0
    v_mov_b32 v34, 0
    v_mov_b32 v35, 0
    v_mov_b32 v36, 0
    v_mov_b32 v37, 0
    v_mov_b32 v38, 0
    v_mov_b32 v39, 0
    v_lshrrev_b32 v1, 3, v0
    v_mul_u32_u24 v1, 576, v1
    v_lshlrev_b32 v3, 4, v0
    v_add_u32 v3, 27776, v3
    s_mov_b32 s59, 32
L_ffn_loop:
    ds_read_b128 v[8:11], v1 offset:0
    ds_read_b128 v[64:67], v3 offset:0
    ds_read_b128 v[68:71], v3 offset:1024
    ds_read_b128 v[72:75], v3 offset:2048
    ds_read_b128 v[76:79], v3 offset:3072
    v_add_u32 v1, 16, v1
    v_add_u32 v3, 4096, v3
    s_waitcnt lgkmcnt(0)
    v_and_b32 v56, v8, v4
    v_and_b32 v57, v8, v5
    v_and_b32 v58, v8, v6
    v_and_b32 v59, v8, v7
    v_and_b32 v60, v9, v4
    v_and_b32 v61, v9, v5
    v_and_b32 v62, v9, v6
    v_and_b32 v63, v9, v7
    v_mfma_f32_16x16x32_bf16 v[24:27], v[56:59], v[64:67], v[24:27]
    s_nop 0
    v_mfma_f32_16x16x32_bf16 v[28:31], v[60:63], v[64:67], v[28:31]
    v_mfma_f32_16x16x32_bf16 v[32:35], v[56:59], v[68:71], v[32:35]
    v_mfma_f32_16x16x32_bf16 v[36:39], v[60:63], v[68:71], v[36:39]
    v_and_b32 v56, v10, v4
    v_and_b32 v57, v10, v5
    v_and_b32 v58, v10, v6
    v_and_b32 v59, v10, v7
    v_and_b32 v60, v11, v4
    v_and_b32 v61, v11, v5
    v_and_b32 v62, v11, v6
    v_and_b32 v63, v11, v7
    v_mfma_f32_16x16x32_bf16 v[24:27], v[56:59], v[72:75], v[24:27]
    s_nop 0
    v_mfma_f32_16x16x32_bf16 v[28:31], v[60:63], v[72:75], v[28:31]
    v_mfma_f32_16x16x32_bf16 v[32:35], v[56:59], v[76:79], v[32:35]
    v_mfma_f32_16x16x32_bf16 v[36:39], v[60:63], v[76:79], v[36:39]
    s_sub_u32 s59, s59, 1
    s_cmp_lg_u32 s59, 0
    s_cbranch_scc1 L_ffn_loop
    ds_read_b128 v[8:11], v1 offset:0
    s_waitcnt lgkmcnt(0)
    v_and_b32 v56, v8, v4
    v_and_b32 v57, v8, v5
    v_and_b32 v58, v8, v6
    v_and_b32 v59, v8, v7
    v_and_b32 v60, v9, v4
    v_and_b32 v61, v9, v5
    v_and_b32 v62, v9, v6
    v_and_b32 v63, v9, v7
    v_mfma_f32_16x16x32_bf16 v[24:27], v[56:59], v[128:131], v[24:27]
    s_nop 0
    v_mfma_f32_16x16x32_bf16 v[28:31], v[60:63], v[128:131], v[28:31]
    v_mfma_f32_16x16x32_bf16 v[32:35], v[56:59], v[132:135], v[32:35]
    v_mfma_f32_16x16x32_bf16 v[36:39], v[60:63], v[132:135], v[36:39]
    v_and_b32 v56, v10, v4
    v_and_b32 v57, v10, v5
    v_and_b32 v58, v10, v6
    v_and_b32 v59, v10, v7
    v_and_b32 v60, v11, v4
    v_and_b32 v61, v11, v5
    v_and_b32 v62, v11, v6
    v_and_b32 v63, v11, v7
    v_mfma_f32_16x16x32_bf16 v[24:27], v[56:59], v[136:139], v[24:27]
    s_nop 0
    v_mfma_f32_16x16x32_bf16 v[28:31], v[60:63], v[136:139], v[28:31]
    v_mfma_f32_16x16x32_bf16 v[32:35], v[56:59], v[140:143], v[32:35]
    v_mfma_f32_16x16x32_bf16 v[36:39], v[60:63], v[140:143], v[36:39]
    ds_read_b128 v[8:11], v1 offset:16
    s_waitcnt lgkmcnt(0)
    v_and_b32 v56, v8, v4
    v_and_b32 v57, v8, v5
    v_and_b32 v58, v8, v6
    v_and_b32 v59, v8, v7
    v_and_b32 v60, v9, v4
    v_and_b32 v61, v9, v5
    v_and_b32 v62, v9, v6
    v_and_b32 v63, v9, v7
    v_mfma_f32_16x16x32_bf16 v[24:27], v[56:59], v[144:147], v[24:27]
    s_nop 0
    v_mfma_f32_16x16x32_bf16 v[28:31], v[60:63], v[144:147], v[28:31]
    v_mfma_f32_16x16x32_bf16 v[32:35], v[56:59], v[148:151], v[32:35]
    v_mfma_f32_16x16x32_bf16 v[36:39], v[60:63], v[148:151], v[36:39]
    v_and_b32 v56, v10, v4
    v_and_b32 v57, v10, v5
    v_and_b32 v58, v10, v6
    v_and_b32 v59, v10, v7
    v_and_b32 v60, v11, v4
    v_and_b32 v61, v11, v5
    v_and_b32 v62, v11, v6
    v_and_b32 v63, v11, v7
    v_mfma_f32_16x16x32_bf16 v[24:27], v[56:59], v[152:155], v[24:27]
    s_nop 0
    v_mfma_f32_16x16x32_bf16 v[28:31], v[60:63], v[152:155], v[28:31]
    v_mfma_f32_16x16x32_bf16 v[32:35], v[56:59], v[156:159], v[32:35]
    v_mfma_f32_16x16x32_bf16 v[36:39], v[60:63], v[156:159], v[36:39]
    ds_read_b128 v[8:11], v1 offset:32
    s_waitcnt lgkmcnt(0)
    v_and_b32 v56, v8, v4
    v_and_b32 v57, v8, v5
    v_and_b32 v58, v8, v6
    v_and_b32 v59, v8, v7
    v_and_b32 v60, v9, v4
    v_and_b32 v61, v9, v5
    v_and_b32 v62, v9, v6
    v_and_b32 v63, v9, v7
    v_mfma_f32_16x16x32_bf16 v[24:27], v[56:59], v[160:163], v[24:27]
    s_nop 0
    v_mfma_f32_16x16x32_bf16 v[28:31], v[60:63], v[160:163], v[28:31]
    v_mfma_f32_16x16x32_bf16 v[32:35], v[56:59], v[164:167], v[32:35]
    v_mfma_f32_16x16x32_bf16 v[36:39], v[60:63], v[164:167], v[36:39]
    v_and_b32 v56, v10, v4
    v_and_b32 v57, v10, v5
    v_and_b32 v58, v10, v6
    v_and_b32 v59, v10, v7
    v_and_b32 v60, v11, v4
    v_and_b32 v61, v11, v5
    v_and_b32 v62, v11, v6
    v_and_b32 v63, v11, v7
    v_mfma_f32_16x16x32_bf16 v[24:27], v[56:59], v[168:171], v[24:27]
    s_nop 0
    v_mfma_f32_16x16x32_bf16 v[28:31], v[60:63], v[168:171], v[28:31]
    v_mfma_f32_16x16x32_bf16 v[32:35], v[56:59], v[172:175], v[32:35]
    v_mfma_f32_16x16x32_bf16 v[36:39], v[60:63], v[172:175], v[36:39]
    ds_read_b128 v[8:11], v1 offset:48
    s_waitcnt lgkmcnt(0)
    v_and_b32 v56, v8, v4
    v_and_b32 v57, v8, v5
    v_and_b32 v58, v8, v6
    v_and_b32 v59, v8, v7
    v_and_b32 v60, v9, v4
    v_and_b32 v61, v9, v5
    v_and_b32 v62, v9, v6
    v_and_b32 v63, v9, v7
    v_mfma_f32_16x16x32_bf16 v[24:27], v[56:59], v[176:179], v[24:27]
    s_nop 0
    v_mfma_f32_16x16x32_bf16 v[28:31], v[60:63], v[176:179], v[28:31]
    v_mfma_f32_16x16x32_bf16 v[32:35], v[56:59], v[180:183], v[32:35]
    v_mfma_f32_16x16x32_bf16 v[36:39], v[60:63], v[180:183], v[36:39]
    v_and_b32 v56, v10, v4
    v_and_b32 v57, v10, v5
    v_and_b32 v58, v10, v6
    v_and_b32 v59, v10, v7
    v_and_b32 v60, v11, v4
    v_and_b32 v61, v11, v5
    v_and_b32 v62, v11, v6
    v_and_b32 v63, v11, v7
    v_mfma_f32_16x16x32_bf16 v[24:27], v[56:59], v[184:187], v[24:27]
    s_nop 0
    v_mfma_f32_16x16x32_bf16 v[28:31], v[60:63], v[184:187], v[28:31]
    v_mfma_f32_16x16x32_bf16 v[32:35], v[56:59], v[188:191], v[32:35]
    v_mfma_f32_16x16x32_bf16 v[36:39], v[60:63], v[188:191], v[36:39]
    v_lshrrev_b32 v1, 5, v0
    v_lshlrev_b32 v1, 7, v1
    v_and_b32 v2, 7, v0
    v_lshl_add_u32 v1, v2, 3, v1
    v_bfe_u32 v2, v0, 4, 1
    v_lshl_add_u32 v1, v2, 2, v1
    v_add_f32_dpp v24, v28, v24 row_ror:8 row_mask:0xf bank_mask:0xf
    s_nop 0
    v_add_f32_dpp v32, v36, v32 row_ror:8 row_mask:0xf bank_mask:0xf
    v_add_f32_dpp v25, v29, v25 row_ror:8 row_mask:0xf bank_mask:0xf
    v_add_f32_dpp v33, v37, v33 row_ror:8 row_mask:0xf bank_mask:0xf
    v_add_f32_dpp v26, v30, v26 row_ror:8 row_mask:0xf bank_mask:0xf
    v_add_f32_dpp v34, v38, v34 row_ror:8 row_mask:0xf bank_mask:0xf
    v_add_f32_dpp v27, v31, v27 row_ror:8 row_mask:0xf bank_mask:0xf
    v_add_f32_dpp v35, v39, v35 row_ror:8 row_mask:0xf bank_mask:0xf
    v_cvt_pk_bf16_f32 v24, v24, v24
    v_and_b32 v24, 0xffff0000, v24
    v_cvt_pk_bf16_f32 v32, v32, v32
    v_and_b32 v32, 0xffff0000, v32
    v_mul_f32 v28, s65, v24
    v_exp_f32 v28, v28
    s_nop 0
    v_add_f32 v28, 1.0, v28
    v_rcp_f32 v28, v28
    s_nop 0
    v_mul_f32 v24, v24, v28
    v_cvt_pk_bf16_f32 v24, v24, v24
    v_and_b32 v24, 0xffff0000, v24
    v_mul_f32 v24, v24, v32
    v_cvt_pk_bf16_f32 v24, v24, v24
    v_cvt_pk_bf16_f32 v25, v25, v25
    v_and_b32 v25, 0xffff0000, v25
    v_cvt_pk_bf16_f32 v33, v33, v33
    v_and_b32 v33, 0xffff0000, v33
    v_mul_f32 v29, s65, v25
    v_exp_f32 v29, v29
    s_nop 0
    v_add_f32 v29, 1.0, v29
    v_rcp_f32 v29, v29
    s_nop 0
    v_mul_f32 v25, v25, v29
    v_cvt_pk_bf16_f32 v25, v25, v25
    v_and_b32 v25, 0xffff0000, v25
    v_mul_f32 v25, v25, v33
    v_cvt_pk_bf16_f32 v25, v25, v25
    v_cvt_pk_bf16_f32 v26, v26, v26
    v_and_b32 v26, 0xffff0000, v26
    v_cvt_pk_bf16_f32 v34, v34, v34
    v_and_b32 v34, 0xffff0000, v34
    v_mul_f32 v30, s65, v26
    v_exp_f32 v30, v30
    s_nop 0
    v_add_f32 v30, 1.0, v30
    v_rcp_f32 v30, v30
    s_nop 0
    v_mul_f32 v26, v26, v30
    v_cvt_pk_bf16_f32 v26, v26, v26
    v_and_b32 v26, 0xffff0000, v26
    v_mul_f32 v26, v26, v34
    v_cvt_pk_bf16_f32 v26, v26, v26
    v_cvt_pk_bf16_f32 v27, v27, v27
    v_and_b32 v27, 0xffff0000, v27
    v_cvt_pk_bf16_f32 v35, v35, v35
    v_and_b32 v35, 0xffff0000, v35
    v_mul_f32 v31, s65, v27
    v_exp_f32 v31, v31
    s_nop 0
    v_add_f32 v31, 1.0, v31
    v_rcp_f32 v31, v31
    s_nop 0
    v_mul_f32 v27, v27, v31
    v_cvt_pk_bf16_f32 v27, v27, v27
    v_and_b32 v27, 0xffff0000, v27
    v_mul_f32 v27, v27, v35
    v_cvt_pk_bf16_f32 v27, v27, v27
    s_mov_b64 exec, s[70:71]
    ds_write_b32 v1, v24 offset:5120
    ds_write_b32 v1, v25 offset:5376
    ds_write_b32 v1, v26 offset:5632
    ds_write_b32 v1, v27 offset:5888
    s_mov_b64 exec, -1
L_agent:
    v_mov_b32 v1, 0
    s_mov_b32 s59, 464
    s_cmp_eq_u32 s56, 1
    s_cselect_b32 s59, 432, s59
    s_lshr_b32 s61, s52, 3
    s_xor_b32 s61, s61, s52
    s_and_b32 s61, s61, 3
    s_cselect_b32 s82, 16, 24
    s_add_u32 s83, s82, 16
    s_mov_b32 s61, 0
    s_cmp_eq_u32 s56, 1
    s_cselect_b32 s61, 10, s61
    s_cmp_eq_u32 s56, 3
    s_cselect_b32 s61, 13, s61
    s_sub_u32 s74, s83, s61
L_ag_wait:
    s_sleep 2
    ds_read_b128 v[8:11], v1 offset:10320
    s_sub_u32 s61, s59, 12
    s_waitcnt lgkmcnt(0)
    v_min3_u32 v8, v8, v9, v10
    v_min_u32 v8, v8, v11
    v_cmp_gt_u32 vcc, s61, v8
    s_cbranch_vccz L_ag_ok
    s_sub_u32 s66, s66, 1
    s_cmp_gt_i32 s66, 0
    s_cbranch_scc1 L_ag_wait
L_ag_ok:
    v_mov_b32 v8, 1
    s_mov_b64 exec, 1
    buffer_atomic_add v8, off, s[36:39], s75 sc0
    s_mov_b64 exec, -1
    v_mov_b32 v9, s59
    s_waitcnt vmcnt(0)
    v_readfirstlane_b32 s61, v8
    s_add_u32 s59, s59, 8
    s_min_u32 s61, s61, s83
    s_sub_u32 s62, s61, s82
    s_add_u32 s62, s62, 496
    s_lshr_b32 s72, s61, 3
    s_add_u32 s72, s72, s52
    s_add_u32 s72, s72, 1
    s_and_b32 s72, s72, 7
    s_and_b32 s73, s61, 7
    s_add_u32 s73, s73, 54
    s_lshl_b32 s73, s73, 3
    s_add_u32 s72, s72, s73
    s_cmp_lt_u32 s61, s82
    s_cselect_b32 s62, s72, s62
    s_and_b32 s72, s62, 7
    s_lshl_b32 s72, s72, 9
    s_lshr_b32 s62, s62, 3
    s_lshl_b32 s62, s62, 17
    s_add_u32 s62, s62, s72
    s_add_u32 s62, s62, 1056964609
    v_mov_b32 v10, s62
    v_or_b32 v11, 2, v10
    ds_write_b64 v9, v[10:11] offset:10368
    s_cmp_lt_u32 s61, s74
    s_cbranch_scc1 L_ag_wait
    v_mov_b32 v10, 1065353217
    v_or_b32 v11, 2, v10
    ds_write_b64 v9, v[10:11] offset:10376
    s_waitcnt lgkmcnt(0)
    s_cmp_lg_u32 s56, 2
    s_cbranch_scc1 L_end
    s_setprio 3
L_red:
    s_mov_b32 s44, s4
    s_mov_b32 s45, s5
    s_mov_b32 s46, 2304
    s_mov_b32 s47, 0x20000
    v_and_b32 v18, 3, v0
    v_lshlrev_b32 v18, 2, v18
    v_lshrrev_b32 v2, 4, v0
    v_add_lshl_u32 v18, v18, v2, 1
    s_lshl_b32 s59, s57, 5
    buffer_load_ushort v19, v18, s[44:47], s59 offen
    s_lshr_b32 s61, s57, 1
    s_and_b32 s62, s57, 1
    s_lshl_b32 s62, s62, 6
    s_mul_i32 s58, s61, 9216
    s_add_u32 s58, s58, s62
    s_add_u32 s58, s58, 1048576
    s_lshl_b32 s61, s61, 13
    s_add_u32 s61, s61, s62
    s_add_u32 s61, s61, 720896
    v_lshrrev_b32 v1, 2, v0
    v_lshlrev_b32 v1, 7, v1
    v_and_b32 v2, 3, v0
    v_lshl_add_u32 v1, v2, 4, v1
    v_add_u32 v2, 4096, v1
    v_and_b32 v3, 0x3ff, v1
    v_add_u32 v3, 8192, v3
    s_mov_b32 s80, 0x000f000f
    s_mov_b32 s81, 0x000f000f
    s_barrier
L_dp_poll:
    buffer_load_dwordx4 v[84:87], v1, s[36:39], s58 offen offset:0 sc1
    buffer_load_dwordx4 v[88:91], v1, s[36:39], s58 offen offset:2048 sc1
    buffer_load_dwordx4 v[92:95], v2, s[36:39], s58 offen offset:0 sc1
    buffer_load_dwordx4 v[96:99], v2, s[36:39], s58 offen offset:2048 sc1
    buffer_load_dwordx4 v[100:103], v3, s[36:39], s58 offen offset:0 sc1
    buffer_load_dwordx4 v[64:67], v1, s[36:39], s61 offen offset:0 sc1
    buffer_load_dwordx4 v[68:71], v1, s[36:39], s61 offen offset:2048 sc1
    buffer_load_dwordx4 v[72:75], v2, s[36:39], s61 offen offset:0 sc1
    buffer_load_dwordx4 v[76:79], v2, s[36:39], s61 offen offset:2048 sc1
    s_waitcnt vmcnt(4)
    v_xor_b32 v8, s76, v84
    v_xor_b32 v9, s77, v85
    v_bitop3_b32 v8, v86, s78, v8 bitop3:0xbe
    v_bitop3_b32 v9, v87, s79, v9 bitop3:0xbe
    v_bitop3_b32 v8, v88, s76, v8 bitop3:0xbe
    v_bitop3_b32 v9, v89, s77, v9 bitop3:0xbe
    v_bitop3_b32 v8, v90, s78, v8 bitop3:0xbe
    v_bitop3_b32 v9, v91, s79, v9 bitop3:0xbe
    v_bitop3_b32 v8, v92, s76, v8 bitop3:0xbe
    v_bitop3_b32 v9, v93, s77, v9 bitop3:0xbe
    v_bitop3_b32 v8, v94, s78, v8 bitop3:0xbe
    v_bitop3_b32 v9, v95, s79, v9 bitop3:0xbe
    v_bitop3_b32 v8, v96, s76, v8 bitop3:0xbe
    v_bitop3_b32 v9, v97, s77, v9 bitop3:0xbe
    v_bitop3_b32 v8, v98, s78, v8 bitop3:0xbe
    v_bitop3_b32 v9, v99, s79, v9 bitop3:0xbe
    v_bitop3_b32 v8, v100, s76, v8 bitop3:0xbe
    v_bitop3_b32 v9, v101, s77, v9 bitop3:0xbe
    v_bitop3_b32 v8, v102, s78, v8 bitop3:0xbe
    v_bitop3_b32 v9, v103, s79, v9 bitop3:0xbe
    v_bitop3_b32 v8, v8, v9, 15 bitop3:0xa8
    v_cmp_ne_u32 vcc, 0, v8
    s_cbranch_vccz L_dp_ok
    s_sub_u32 s66, s66, 1
    s_cmp_gt_i32 s66, 0
    s_cbranch_scc1 L_dp_poll
L_dp_ok:
    v_cndmask_b32 v100, v100, 0, s[68:69]
    v_cndmask_b32 v101, v101, 0, s[68:69]
    v_cndmask_b32 v102, v102, 0, s[68:69]
    v_cndmask_b32 v103, v103, 0, s[68:69]
    v_add_f32 v84, v84, v88
    v_add_f32 v92, v92, v96
    v_add_f32 v85, v85, v89
    v_add_f32 v93, v93, v97
    v_add_f32 v86, v86, v90
    v_add_f32 v94, v94, v98
    v_add_f32 v87, v87, v91
    v_add_f32 v95, v95, v99
    v_add_f32 v84, v84, v100
    v_add_f32 v85, v85, v101
    v_add_f32 v86, v86, v102
    v_add_f32 v87, v87, v103
    v_add_f32 v84, v84, v92
    v_add_f32 v85, v85, v93
    v_add_f32 v86, v86, v94
    v_add_f32 v87, v87, v95
    s_nop 0
    v_permlane32_swap_b32 v84, v86
    v_permlane32_swap_b32 v85, v87
    v_add_f32 v84, v84, v86
    v_add_f32 v85, v85, v87
    s_nop 1
    v_permlane16_swap_b32 v84, v85
    v_add_f32 v84, v84, v85
    s_nop 1
    v_add_f32_dpp v84, v84, v84 row_ror:4 row_mask:0xf bank_mask:0xf
    s_nop 1
    v_add_f32_dpp v84, v84, v84 row_ror:8 row_mask:0xf bank_mask:0xf
    v_cvt_pk_bf16_f32 v24, v84, v84
    v_and_b32 v24, 0xffff0000, v24
    v_mul_f32 v26, s65, v24
    v_exp_f32 v26, v26
    s_nop 0
    v_add_f32 v26, 1.0, v26
    v_rcp_f32 v26, v26
    s_nop 0
    v_mul_f32 v24, v24, v26
    v_cvt_pk_bf16_f32 v24, v24, v24
    v_and_b32 v24, 0xffff0000, v24
    v_lshlrev_b32 v26, 16, v19
    s_branch L_sp_chk
L_sp_poll:
    buffer_load_dwordx4 v[64:67], v1, s[36:39], s61 offen offset:0 sc1
    buffer_load_dwordx4 v[68:71], v1, s[36:39], s61 offen offset:2048 sc1
    buffer_load_dwordx4 v[72:75], v2, s[36:39], s61 offen offset:0 sc1
    buffer_load_dwordx4 v[76:79], v2, s[36:39], s61 offen offset:2048 sc1
L_sp_chk:
    s_waitcnt vmcnt(0)
    v_xor_b32 v8, s76, v64
    v_xor_b32 v9, s77, v65
    v_bitop3_b32 v8, v66, s78, v8 bitop3:0xbe
    v_bitop3_b32 v9, v67, s79, v9 bitop3:0xbe
    v_bitop3_b32 v8, v68, s76, v8 bitop3:0xbe
    v_bitop3_b32 v9, v69, s77, v9 bitop3:0xbe
    v_bitop3_b32 v8, v70, s78, v8 bitop3:0xbe
    v_bitop3_b32 v9, v71, s79, v9 bitop3:0xbe
    v_bitop3_b32 v8, v72, s76, v8 bitop3:0xbe
    v_bitop3_b32 v9, v73, s77, v9 bitop3:0xbe
    v_bitop3_b32 v8, v74, s78, v8 bitop3:0xbe
    v_bitop3_b32 v9, v75, s79, v9 bitop3:0xbe
    v_bitop3_b32 v8, v76, s76, v8 bitop3:0xbe
    v_bitop3_b32 v9, v77, s77, v9 bitop3:0xbe
    v_bitop3_b32 v8, v78, s78, v8 bitop3:0xbe
    v_bitop3_b32 v9, v79, s79, v9 bitop3:0xbe
    v_bitop3_b32 v8, v8, v9, 15 bitop3:0xa8
    v_cmp_ne_u32 vcc, 0, v8
    s_cbranch_vccz L_sp_ok
    s_sub_u32 s66, s66, 1
    s_cmp_gt_i32 s66, 0
    s_cbranch_scc1 L_sp_poll
L_sp_ok:
    v_add_f32 v64, v64, v68
    v_add_f32 v72, v72, v76
    v_add_f32 v65, v65, v69
    v_add_f32 v73, v73, v77
    v_add_f32 v66, v66, v70
    v_add_f32 v74, v74, v78
    v_add_f32 v67, v67, v71
    v_add_f32 v75, v75, v79
    v_add_f32 v64, v64, v72
    v_add_f32 v65, v65, v73
    v_add_f32 v66, v66, v74
    v_add_f32 v67, v67, v75
    s_nop 0
    v_permlane32_swap_b32 v64, v66
    v_permlane32_swap_b32 v65, v67
    v_add_f32 v64, v64, v66
    v_add_f32 v65, v65, v67
    s_nop 1
    v_permlane16_swap_b32 v64, v65
    v_add_f32 v64, v64, v65
    s_nop 1
    v_add_f32_dpp v64, v64, v64 row_ror:4 row_mask:0xf bank_mask:0xf
    s_nop 1
    v_add_f32_dpp v64, v64, v64 row_ror:8 row_mask:0xf bank_mask:0xf
    v_cvt_pk_bf16_f32 v28, v64, v64
    v_and_b32 v28, 0xffff0000, v28
    v_mul_f32 v28, v28, v24
    v_cvt_pk_bf16_f32 v28, v28, v28
    v_and_b32 v28, 0xffff0000, v28
    v_add_f32 v28, v28, v26
    v_cvt_pk_bf16_f32 v28, v28, v28
    s_mov_b64 exec, s[80:81]
    buffer_store_short v28, v18, s[48:51], s59 offen
    s_cmp_lg_u32 s57, 0
    s_cbranch_scc1 L_end
    s_mov_b64 exec, 1
    v_mov_b32 v1, s76
    buffer_store_dword v1, off, s[36:39], 0
L_end:
    s_endpgm
.fill 1024, 4, 0xbf810000
.section .rodata,"a"
.p2align 6
.amdhsa_kernel recurrent_scan__gqa_block_cached__swiglu_ffn__decode_kernel
  .amdhsa_next_free_vgpr 240
  .amdhsa_next_free_sgpr 100
  .amdhsa_accum_offset 240
  .amdhsa_group_segment_fixed_size 0
  .amdhsa_kernarg_size 96
  .amdhsa_user_sgpr_count 2
  .amdhsa_user_sgpr_kernarg_segment_ptr 1
  .amdhsa_system_sgpr_workgroup_id_x 1
  .amdhsa_float_denorm_mode_32 3
.end_amdhsa_kernel
```
